```python
import torch

def _softmax(x, axis=-1):
    return torch.softmax(x, dim=axis)
def _gelu(x):
    return torch.nn.functional.gelu(x, approximate="tanh")
def _silu(x):
    return torch.nn.functional.silu(x)
def _sigmoid(x):
    return torch.sigmoid(x)
def _layernorm(x, axis=-1, eps=1e-5):
    m = x.mean(dim=axis, keepdim=True)
    v = x.var(dim=axis, keepdim=True, unbiased=False)
    return (x - m) / torch.sqrt(v + eps)
def _scatter_add(tgt, idx, src, axis=0):
    return tgt.clone().index_add_(axis, idx, src)
def _segment_sum(src, seg, n):
    out = torch.zeros((n,) + src.shape[1:], dtype=src.dtype)
    return out.index_add_(0, seg, src)
def _pad(x, pw):
    flat = tuple(v for pair in reversed(pw) for v in pair)
    return torch.nn.functional.pad(x, flat)

kernel_name = 'recurrent_scan__spectral_fnet__mixer_channel_mlp__prompt'

def setup_inputs():

    _w = (lambda a: (lambda t: t.to(torch.bfloat16) if t.is_floating_point() else t)(torch.as_tensor(a)))
    def _A_setup():
        B, S, D = 1, 2048, 512
        ns = torch.arange(S)[:, None] * torch.arange(S)[None, :]
        nd = torch.arange(D)[:, None] * torch.arange(D)[None, :]
        Ws_re = torch.cos(-2.0 * torch.pi * ns / S).to(float)
        Ws_im = torch.sin(-2.0 * torch.pi * ns / S).to(float)
        Wd_re = torch.cos(-2.0 * torch.pi * nd / D).to(float)
        Wd_im = torch.sin(-2.0 * torch.pi * nd / D).to(float)
        return {
            "x": _w((lambda *s: torch.randn(*s, dtype=torch.bfloat16) * 0.05)(B, S, D)),
            "dft_seq_re": _w(Ws_re),
            "dft_seq_im": _w(Ws_im),
            "dft_hid_re": _w(Wd_re),
            "dft_hid_im": _w(Wd_im),
        }
    _A_in = _A_setup()

    def _B_setup():
        B, S, D, F = 1, 2048, 512, 1792
        return {
            "x": _w((lambda *s: torch.randn(*s, dtype=torch.bfloat16) * 0.05)(B, S, D)),
            "w1": _w((lambda *s: torch.randn(*s, dtype=torch.bfloat16) * 0.8)(D, F) * (D ** -0.5)),
            "b1": _w((lambda *s: torch.randn(*s, dtype=torch.bfloat16) * 0.4)(F)),
            "w2": _w((lambda *s: torch.randn(*s, dtype=torch.bfloat16) * 0.05)(F, D) * (F ** -0.5)),
            "b2": _w((lambda *s: torch.randn(*s, dtype=torch.bfloat16) * 0.05)(D)),
        }
    _B_in = _B_setup()

    return {
        "A_x": _A_in["x"],
        "A_dft_seq_re": _A_in["dft_seq_re"],
        "A_dft_seq_im": _A_in["dft_seq_im"],
        "A_dft_hid_re": _A_in["dft_hid_re"],
        "A_dft_hid_im": _A_in["dft_hid_im"],
        "B_x": _B_in["x"],
        "B_w1": _B_in["w1"],
        "B_b1": _B_in["b1"],
        "B_w2": _B_in["w2"],
        "B_b2": _B_in["b2"],
    }

def reference(A_x, A_dft_seq_re, A_dft_seq_im, A_dft_hid_re, A_dft_hid_im, B_x, B_w1, B_b1, B_w2, B_b2):
    def _A_ref(x, dft_seq_re, dft_seq_im, dft_hid_re, dft_hid_im):
        a = torch.einsum("bsd,ed->bse", x, dft_hid_re)
        b = torch.einsum("bsd,ed->bse", x, dft_hid_im)
        y = torch.einsum("ts,bse->bte", dft_seq_re, a) - torch.einsum("ts,bse->bte", dft_seq_im, b)
        return y

    def _B_ref(x, w1, b1, w2, b2):
        y = _layernorm(x, axis=-1)
        h = _gelu(torch.einsum("bsd,df->bsf", y, w1) + b1)
        return torch.einsum("bsf,fd->bsd", h, w2) + b2

    x = A_x
    xn = _layernorm(x, axis=-1)
    s = _A_ref(xn, A_dft_seq_re, A_dft_seq_im, A_dft_hid_re, A_dft_hid_im)
    g = _silu(_B_ref(xn, B_w1, B_b1, B_w2, B_b2))
    return x + s * g
```

```asm
; @launch grid=(256,1,1) block=(256,1,1) lds=163840
.amdgcn_target "amdgcn-amd-amdhsa--gfx950"
.text
.globl recurrent_scan__spectral_fnet__mixer_channel_mlp__prompt_kernel
.p2align 8
.type recurrent_scan__spectral_fnet__mixer_channel_mlp__prompt_kernel,@function
recurrent_scan__spectral_fnet__mixer_channel_mlp__prompt_kernel:
    s_load_dwordx16 s[16:31], s[0:1], 0
    s_getpc_b64 s[14:15]
L_pc:
    s_cmp_ge_u32 s2, 256
    s_cbranch_scc1 L_end
    v_lshlrev_b32 v1, 7, v0
    v_min_u32 v1, L_last-L_pc-4, v1
    global_load_dword v63, v1, s[14:15]
    v_lshrrev_b32 v1, 6, v0
    v_and_b32 v0, 63, v0
    v_readfirstlane_b32 s72, v1
    s_and_b32 s3, s2, 7
    s_lshr_b32 s77, s2, 6
    s_bfe_u32 s78, s2, 0x30003
    s_lshr_b32 s73, s3, 1
    s_lshl2_add_u32 s73, s73, s77
    s_add_u32 s81, s77, s78
    s_lshl_b32 s81, s81, 2
    s_mul_i32 s80, s3, 1
    s_add_u32 s81, s81, s80
    s_and_b32 s98, s81, 7
    s_lshl_b32 s82, s98, 7
    v_lshrrev_b32 v1, 3, v0
    v_lshrrev_b32 v2, 4, v0
    v_and_b32 v3, 7, v0
    s_mul_i32 s98, s72, 17
    s_and_b32 s98, s98, 33
    s_lshl1_add_u32 s14, s73, s98
    v_xor_b32 v3, v3, v2
    v_lshl_add_u32 v1, v1, 6, s14
    v_lshlrev_b32 v3, 4, v3
    v_lshl_add_u32 v4, v1, 10, v3
    s_lshl_b32 s79, s72, 12
    v_xor_b32 v3, 64, v4
    s_mov_b32 m0, s79
    v_add_u32 v5, 523264, v3
    v_add_u32 v6, 1046528, v4
    v_add_u32 v7, 1569792, v3
    s_mov_b32 s34, 2097152
    s_mov_b32 s35, 0x20000
    s_waitcnt lgkmcnt(0)
    s_mov_b64 s[32:33], s[16:17]
    buffer_load_dwordx4 v4, s[32:35], s82 offen offset:0 lds
    buffer_load_dwordx4 v5, s[32:35], s82 offen offset:1024 lds
    buffer_load_dwordx4 v6, s[32:35], s82 offen offset:2048 lds
    buffer_load_dwordx4 v7, s[32:35], s82 offen offset:3072 lds
    s_load_dwordx8 s[4:11], s[0:1], 64
    s_load_dwordx2 s[12:13], s[0:1], 96
    s_and_b32 s74, s3, 1
    s_lshl3_add_u32 s74, s74, s78
    s_and_b32 s75, s74, 3
    s_lshr_b32 s98, s74, 2
    s_mul_i32 s76, s98, 896
    s_mul_i32 s98, s75, 0xe0
    s_add_u32 s98, s98, 64
    s_andn2_b32 s98, s98, 0x7f
    s_add_u32 s76, s76, s98
    v_lshl_add_u32 v1, s72, 4, v2
    v_mul_u32_u24 v1, 0xe00, v1
    v_and_b32 v3, 15, v0
    v_lshlrev_b32 v2, 2, v2
    v_xor_b32 v3, v3, v2
    v_lshl_add_u32 v1, v3, 4, v1
    v_add_u32 v8, s76, v1
    v_add_u32 v9, 13312, v8
    v_add_u32 v10, 26624, v8
    v_add_u32 v11, 39936, v8
    s_mov_b32 s38, 1835008
    s_mov_b32 s39, 0x20000
    s_mul_i32 s90, s82, 1792
    s_add_u32 m0, s79, 49152
    s_mov_b64 s[36:37], s[28:29]
    buffer_load_dwordx4 v8, s[36:39], s90 offen offset:0 lds
    buffer_load_dwordx4 v9, s[36:39], s90 offen offset:1024 lds
    s_add_u32 s98, s82, 0x80
    s_and_b32 s83, s98, 0x3ff
    s_mul_i32 s91, s83, 1792
    s_mov_b32 s98, 0x2103210
    s_cmp_ge_u32 s75, 2
    s_cselect_b32 s98, 0x210210, s98
    s_lshl_b32 s99, s72, 2
    s_lshr_b32 s98, s98, s99
    s_cmp_eq_u32 s75, 3
    s_cselect_b32 s99, 0x1111, 0
    s_add_u32 s98, s98, s99
    s_bfe_u32 s64, s98, 262144
    s_bfe_u32 s65, s98, 262148
    s_bfe_u32 s66, s98, 262152
    s_bfe_u32 s67, s98, 262156
    v_and_b32 v1, 31, v0
    buffer_load_dwordx4 v10, s[36:39], s90 offen offset:2048 lds
    v_bfe_u32 v2, v0, 1, 3
    v_lshrrev_b32 v3, 5, v0
    v_xor_b32 v2, v2, v3
    v_lshlrev_b32 v2, 4, v2
    v_lshl_add_u32 v2, v1, 7, v2
    v_add_u32 v12, s79, v2
    v_xor_b32 v13, 32, v12
    v_xor_b32 v14, 64, v12
    v_xor_b32 v15, 96, v12
    v_bfe_u32 v2, v0, 2, 2
    buffer_load_dwordx4 v11, s[36:39], s90 offen offset:3072 lds
    v_lshl_add_u32 v1, v3, 3, v2
    v_lshlrev_b32 v1, 8, v1
    v_bfe_u32 v52, v0, 4, 1
    v_lshlrev_b32 v54, 5, v52
    v_and_b32 v53, 3, v0
    v_lshl_add_u32 v54, v53, 3, v54
    v_add_u32 v1, v1, v54
    v_add_u32 v1, 49152, v1
    v_xor_b32 v53, s64, v2
    s_add_u32 m0, s79, 16384
    v_lshl_add_u32 v16, v53, 6, v1
    buffer_load_dwordx4 v4, s[32:35], s83 offen offset:0 lds
    v_xor_b32 v53, s65, v2
    v_lshl_add_u32 v17, v53, 6, v1
    v_xor_b32 v53, s66, v2
    v_lshl_add_u32 v18, v53, 6, v1
    v_xor_b32 v53, s67, v2
    v_lshl_add_u32 v19, v53, 6, v1
    v_xor_b32 v1, v52, v2
    v_and_b32 v1, 1, v1
    v_add_u32 v1, -1, v1
    v_and_b32 v20, 0x3f803f80, v1
    buffer_load_dwordx4 v5, s[32:35], s83 offen offset:1024 lds
    v_mov_b32 v21, v20
    v_mov_b32 v22, v20
    v_mov_b32 v23, v20
    s_add_u32 s98, s83, 0x80
    s_and_b32 s84, s98, 0x3ff
    s_mul_i32 s92, s84, 1792
    s_waitcnt lgkmcnt(0)
    s_add_u32 s10, s81, s72
    s_and_b32 s10, s10, 7
    s_lshl_b32 s10, s10, 6
    v_lshlrev_b32 v61, 4, v0
    buffer_load_dwordx4 v6, s[32:35], s83 offen offset:2048 lds
    v_and_b32 v33, 15, v0
    v_lshl_add_u32 v33, s74, 4, v33
    v_mov_b32 v34, 0x100
    v_cmp_eq_u32 vcc, 0, v33
    v_lshl_add_u32 v35, v3, 3, s10
    s_nop 0
    v_cndmask_b32 v33, v33, v34, vcc
    v_cvt_f32_u32 v35, v35
    v_cvt_f32_u32 v33, v33
    v_bfe_u32 v34, v0, 4, 1
    v_mul_f32 v33, 0x3b000000, v33
    buffer_load_dwordx4 v7, s[32:35], s83 offen offset:3072 lds
    v_cvt_f32_u32 v34, v34
    v_mul_f32 v34, 0xbe800000, v34
    v_fmac_f32 v34, v33, v35
    v_add_u32 v35, s79, v61
    v_add_u32 v35, 147456, v35
    v_cos_f32 v36, v33
    s_nop 0
    v_add_f32 v36, v36, v36
    v_fmamk_f32 v64, v33, 0x00000000, v34
    v_fmamk_f32 v65, v33, 0x3f800000, v34
    v_fmamk_f32 v72, v33, 0x41800000, v34
    v_fmamk_f32 v73, v33, 0x41880000, v34
    v_cos_f32 v64, v64
    v_cos_f32 v65, v65
    v_cos_f32 v72, v72
    v_cos_f32 v73, v73
    v_fma_f32 v66, v36, v65, -v64
    v_fma_f32 v74, v36, v73, -v72
    v_fma_f32 v67, v36, v66, -v65
    v_fma_f32 v75, v36, v74, -v73
    v_fma_f32 v68, v36, v67, -v66
    v_fma_f32 v76, v36, v75, -v74
    v_fma_f32 v69, v36, v68, -v67
    v_fma_f32 v77, v36, v76, -v75
    v_fma_f32 v70, v36, v69, -v68
    v_fma_f32 v78, v36, v77, -v76
    v_fma_f32 v71, v36, v70, -v69
    v_fma_f32 v79, v36, v78, -v77
    v_cvt_pk_bf16_f32 v80, v64, v65
    v_cvt_pk_bf16_f32 v81, v66, v67
    v_cvt_pk_bf16_f32 v82, v68, v69
    v_cvt_pk_bf16_f32 v83, v70, v71
    ds_write_b128 v35, v[80:83] offset:0
    v_cvt_pk_bf16_f32 v84, v72, v73
    v_cvt_pk_bf16_f32 v85, v74, v75
    v_cvt_pk_bf16_f32 v86, v76, v77
    v_cvt_pk_bf16_f32 v87, v78, v79
    ds_write_b128 v35, v[84:87] offset:1024
    v_fmamk_f32 v64, v33, 0x42000000, v34
    v_fmamk_f32 v65, v33, 0x42040000, v34
    v_fmamk_f32 v72, v33, 0x42400000, v34
    v_fmamk_f32 v73, v33, 0x42440000, v34
    v_cos_f32 v64, v64
    v_cos_f32 v65, v65
    v_cos_f32 v72, v72
    v_cos_f32 v73, v73
    v_fma_f32 v66, v36, v65, -v64
    v_fma_f32 v74, v36, v73, -v72
    v_fma_f32 v67, v36, v66, -v65
    v_fma_f32 v75, v36, v74, -v73
    v_fma_f32 v68, v36, v67, -v66
    v_fma_f32 v76, v36, v75, -v74
    v_fma_f32 v69, v36, v68, -v67
    v_fma_f32 v77, v36, v76, -v75
    v_fma_f32 v70, v36, v69, -v68
    v_fma_f32 v78, v36, v77, -v76
    v_fma_f32 v71, v36, v70, -v69
    v_fma_f32 v79, v36, v78, -v77
    v_cvt_pk_bf16_f32 v80, v64, v65
    v_cvt_pk_bf16_f32 v81, v66, v67
    v_cvt_pk_bf16_f32 v82, v68, v69
    v_cvt_pk_bf16_f32 v83, v70, v71
    ds_write_b128 v35, v[80:83] offset:2048
    v_cvt_pk_bf16_f32 v84, v72, v73
    v_cvt_pk_bf16_f32 v85, v74, v75
    v_cvt_pk_bf16_f32 v86, v76, v77
    v_cvt_pk_bf16_f32 v87, v78, v79
    ds_write_b128 v35, v[84:87] offset:3072
    v_and_b32 v33, 15, v0
    v_cvt_f32_u32 v33, v33
    v_mul_f32 v33, 0x3d000000, v33
    s_lshr_b32 s98, s72, 1
    s_lshl_b32 s98, s98, 4
    v_lshl_add_u32 v34, v3, 2, s98
    v_cvt_f32_u32 v34, v34
    s_and_b32 s98, s72, 1
    v_subrev_u32 v35, s98, v52
    v_cvt_f32_i32 v35, v35
    v_mul_f32 v35, 0x3e800000, v35
    v_fmac_f32 v35, v33, v34
    v_fmamk_f32 v64, v33, 0x00000000, v35
    v_fmamk_f32 v65, v33, 0x3f800000, v35
    v_fmamk_f32 v66, v33, 0x40000000, v35
    v_fmamk_f32 v67, v33, 0x40400000, v35
    v_fmamk_f32 v68, v33, 0x41000000, v35
    v_fmamk_f32 v69, v33, 0x41100000, v35
    v_fmamk_f32 v70, v33, 0x41200000, v35
    v_fmamk_f32 v71, v33, 0x41300000, v35
    v_cos_f32 v64, v64
    v_cos_f32 v65, v65
    v_cos_f32 v66, v66
    v_cos_f32 v67, v67
    v_cos_f32 v68, v68
    v_cos_f32 v69, v69
    v_cos_f32 v70, v70
    v_cos_f32 v71, v71
    s_lshl_b32 s98, s72, 10
    s_add_u32 s98, s98, 133120
    v_add_u32 v35, s98, v61
    v_cvt_pk_bf16_f32 v72, v64, v65
    v_cvt_pk_bf16_f32 v73, v66, v67
    v_cvt_pk_bf16_f32 v74, v68, v69
    v_cvt_pk_bf16_f32 v75, v70, v71
    s_add_u32 m0, s79, 65536
    ds_write_b128 v35, v[72:75]
    buffer_load_dwordx4 v8, s[36:39], s91 offen offset:0 lds
    buffer_load_dwordx4 v9, s[36:39], s91 offen offset:1024 lds
    buffer_load_dwordx4 v10, s[36:39], s91 offen offset:2048 lds
    buffer_load_dwordx4 v11, s[36:39], s91 offen offset:3072 lds
    s_mov_b64 s[40:41], s[4:5]
    s_mov_b32 s42, 1835008
    s_mov_b32 s43, 0x20000
    s_mov_b64 s[60:61], s[6:7]
    s_mov_b32 s62, 1024
    s_mov_b32 s63, 0x20000
    s_mov_b64 s[52:53], s[8:9]
    s_mov_b32 s54, 2097152
    s_mov_b32 s55, 0x20000
    s_mov_b64 s[44:45], s[12:13]
    s_mov_b32 s46, 16777216
    s_mov_b32 s47, 0x20000
    s_mov_b64 s[56:57], s[30:31]
    s_mov_b32 s58, 3584
    s_mov_b32 s59, 0x20000
    v_mov_b32 v64, 0
    s_mov_b32 s28, 7536640
    buffer_load_dword v39, v64, s[44:47], s28 offen sc1
    s_lshl_b32 s28, s74, 7
    s_add_u32 s28, s28, s14
    s_lshl_b32 s28, s28, 10
    buffer_load_dwordx4 v[28:31], v61, s[32:35], s28 offen
    s_add_u32 s28, s28, 0x10000
    buffer_load_dwordx4 v[32:35], v61, s[32:35], s28 offen
    v_and_b32 v64, 31, v0
    s_lshl_b32 s28, s64, 6
    s_add_u32 s28, s28, s76
    v_lshlrev_b32 v64, 1, v64
    s_and_b32 s29, s72, 1
    s_lshl1_add_u32 s29, s78, s29
    s_lshl_b32 s29, s29, 6
    buffer_load_ushort v53, v64, s[60:63], s29 offen
    buffer_load_ushort v38, v64, s[56:59], s28 offen
    s_mov_b32 s31, 0x3f803f80
    s_add_u32 s98, s84, 0x80
    s_and_b32 s85, s98, 0x3ff
    s_mul_i32 s93, s85, 1792
    s_waitcnt vmcnt(13) lgkmcnt(0)
    s_barrier
    s_cmp_ge_u32 s75, 2
    s_cbranch_scc1 L_loop3
    ds_read_b128 v[128:131], v12 offset:0
    ds_read_b64_tr_b16 a[224:225], v16 offset:0
    ds_read_b64_tr_b16 a[226:227], v16 offset:1024
    ds_read_b64_tr_b16 a[228:229], v17 offset:0
    ds_read_b64_tr_b16 a[230:231], v17 offset:1024
    ds_read_b64_tr_b16 a[232:233], v18 offset:0
    ds_read_b64_tr_b16 a[234:235], v18 offset:1024
    ds_read_b64_tr_b16 a[236:237], v19 offset:0
    ds_read_b64_tr_b16 a[238:239], v19 offset:1024
    s_waitcnt lgkmcnt(6)
    v_mfma_f32_32x32x16_bf16 v[64:79], a[224:227], v[128:131], 0
    ds_read_b128 v[132:135], v13 offset:0
    ds_read_b64_tr_b16 a[240:241], v16 offset:4096
    ds_read_b64_tr_b16 a[242:243], v16 offset:5120
    s_and_b32 s80, s78, 1
    s_mul_i32 s80, s80, 4
    s_mul_i32 s98, s3, 1
    s_add_u32 s80, s80, s98
    s_waitcnt lgkmcnt(7)
    v_mfma_f32_32x32x16_bf16 v[80:95], a[228:231], v[128:131], 0
    ds_read_b64_tr_b16 a[244:245], v17 offset:4096
    s_add_u32 m0, s79, 32768
    ds_read_b64_tr_b16 a[246:247], v17 offset:5120
    buffer_load_dwordx4 v4, s[32:35], s84 offen offset:0 lds
    buffer_load_dwordx4 v5, s[32:35], s84 offen offset:1024 lds
    s_waitcnt lgkmcnt(7)
    v_mfma_f32_32x32x16_bf16 v[96:111], a[232:235], v[128:131], 0
    ds_read_b64_tr_b16 a[248:249], v18 offset:4096
    ds_read_b64_tr_b16 a[250:251], v18 offset:5120
    buffer_load_dwordx4 v6, s[32:35], s84 offen offset:2048 lds
    s_waitcnt lgkmcnt(7)
    v_mfma_f32_32x32x16_bf16 v[112:127], a[236:239], v[128:131], 0
    ds_read_b64_tr_b16 a[252:253], v19 offset:4096
    ds_read_b64_tr_b16 a[254:255], v19 offset:5120
    s_and_b32 s98, s77, 1
    s_mul_i32 s98, s98, 0
    s_add_u32 s80, s80, s98
    s_lshl2_add_u32 s77, s3, s77
    s_cmp_ge_u32 s80, 14
    s_cselect_b32 s98, 14, 0
    s_sub_u32 s80, s80, s98
    s_cmp_ge_u32 s80, 7
    s_cselect_b32 s98, 7, 0
    s_sub_u32 s80, s80, s98
    s_lshl_b32 s80, s80, 2
    s_mov_b32 s98, 0x06543210
    s_mov_b32 s99, 0x654321
    s_lshr_b64 s[98:99], s[98:99], s80
    v_mfma_f32_16x16x32_bf16 v[24:27], a[224:227], v[20:23], 0
    s_bfe_u32 s3, s98, 262144
    s_lshl_b32 s16, s3, 12
    s_bfe_u32 s3, s98, 262148
    s_lshl_b32 s17, s3, 12
    s_bfe_u32 s3, s98, 262152
    s_waitcnt lgkmcnt(6)
    v_mfma_f32_32x32x16_bf16 v[64:79], a[240:243], v[132:135], v[64:79]
    ds_read_b128 v[136:139], v14 offset:0
    ds_read_b64_tr_b16 a[224:225], v16 offset:8192
    ds_read_b64_tr_b16 a[226:227], v16 offset:9216
    s_lshl_b32 s18, s3, 12
    s_bfe_u32 s3, s98, 262156
    s_lshl_b32 s19, s3, 12
    s_bfe_u32 s3, s98, 262160
    s_waitcnt lgkmcnt(7)
    v_mfma_f32_32x32x16_bf16 v[80:95], a[244:247], v[132:135], v[80:95]
    ds_read_b64_tr_b16 a[228:229], v17 offset:8192
    ds_read_b64_tr_b16 a[230:231], v17 offset:9216
    buffer_load_dwordx4 v7, s[32:35], s84 offen offset:3072 lds
    s_add_u32 m0, s79, 81920
    s_nop 0
    buffer_load_dwordx4 v8, s[36:39], s92 offen offset:0 lds
    s_waitcnt lgkmcnt(7)
    v_mfma_f32_32x32x16_bf16 v[96:111], a[248:251], v[132:135], v[96:111]
    ds_read_b64_tr_b16 a[232:233], v18 offset:8192
    ds_read_b64_tr_b16 a[234:235], v18 offset:9216
    buffer_load_dwordx4 v9, s[36:39], s92 offen offset:1024 lds
    s_waitcnt lgkmcnt(7)
    v_mfma_f32_32x32x16_bf16 v[112:127], a[252:255], v[132:135], v[112:127]
    ds_read_b64_tr_b16 a[236:237], v19 offset:8192
    ds_read_b64_tr_b16 a[238:239], v19 offset:9216
    s_lshl_b32 s20, s3, 12
    s_bfe_u32 s3, s98, 262164
    s_lshl_b32 s21, s3, 12
    s_bfe_u32 s3, s98, 262168
    s_lshl_b32 s22, s3, 12
    s_mul_i32 s23, s72, 458752
    s_lshl_b32 s3, s78, 7
    s_add_u32 s23, s23, s3
    v_lshrrev_b32 v1, 3, v0
    v_lshlrev_b32 v55, 10, v1
    v_lshlrev_b32 v56, 2, v52
    v_and_b32 v57, 7, v0
    v_xor_b32 v56, v56, v57
    v_mfma_f32_16x16x32_bf16 v[24:27], a[240:243], v[20:23], v[24:27]
    v_lshl_add_u32 v40, v56, 4, v55
    v_add_u32 v41, 7168, v40
    v_add_u32 v42, 14336, v40
    v_add_u32 v43, 21504, v40
    s_lshl_b32 s15, s72, 13
    s_waitcnt lgkmcnt(6)
    v_mfma_f32_32x32x16_bf16 v[64:79], a[224:227], v[136:139], v[64:79]
    ds_read_b128 v[140:143], v15 offset:0
    ds_read_b64_tr_b16 a[240:241], v16 offset:12288
    ds_read_b64_tr_b16 a[242:243], v16 offset:13312
    s_add_u32 s15, s15, 98304
    s_mov_b32 s27, s14
    s_add_u32 s98, s85, 0x80
    s_and_b32 s86, s98, 0x3ff
    s_waitcnt lgkmcnt(7)
    v_mfma_f32_32x32x16_bf16 v[80:95], a[228:231], v[136:139], v[80:95]
    ds_read_b64_tr_b16 a[244:245], v17 offset:12288
    s_add_u32 m0, s79, 81920
    ds_read_b64_tr_b16 a[246:247], v17 offset:13312
    buffer_load_dwordx4 v10, s[36:39], s92 offen offset:2048 lds
    s_waitcnt lgkmcnt(7)
    v_mfma_f32_32x32x16_bf16 v[96:111], a[232:235], v[136:139], v[96:111]
    ds_read_b64_tr_b16 a[248:249], v18 offset:12288
    ds_read_b64_tr_b16 a[250:251], v18 offset:13312
    buffer_load_dwordx4 v11, s[36:39], s92 offen offset:3072 lds
    s_waitcnt lgkmcnt(7)
    v_mfma_f32_32x32x16_bf16 v[112:127], a[236:239], v[136:139], v[112:127]
    ds_read_b64_tr_b16 a[252:253], v19 offset:12288
    ds_read_b64_tr_b16 a[254:255], v19 offset:13312
    s_mul_i32 s94, s86, 1792
    s_add_u32 s98, s86, 0x80
    s_and_b32 s87, s98, 0x3ff
    s_mul_i32 s95, s87, 1792
    s_add_u32 s98, s87, 0x80
    s_and_b32 s88, s98, 0x3ff
    s_mul_i32 s96, s88, 1792
    s_add_u32 s98, s88, 0x80
    s_and_b32 s89, s98, 0x3ff
    s_mul_i32 s97, s89, 1792
    v_lshl_add_u32 v58, v3, 2, v2
    v_lshl_add_u32 v58, v58, 7, v54
    v_mfma_f32_16x16x32_bf16 v[24:27], a[224:227], v[20:23], v[24:27]
    v_bfe_u32 v59, v0, 3, 1
    s_and_b32 s98, s72, 1
    v_xor_b32 v59, s98, v59
    v_lshl_add_u32 v58, v59, 6, v58
    s_lshl_b32 s98, s98, 13
    s_waitcnt lgkmcnt(0)
    s_waitcnt vmcnt(11)
    v_dot2_f32_bf16 v36, v28, s31, 0
    v_dot2_f32_bf16 v37, v28, v28, 0
    s_waitcnt vmcnt(10)
    v_dot2_f32_bf16 v47, v32, s31, 0
    v_dot2_f32_bf16 v63, v32, v32, 0
    v_dot2c_f32_bf16 v36, s31, v29
    v_dot2c_f32_bf16 v37, v29, v29
    v_dot2c_f32_bf16 v47, s31, v33
    v_dot2c_f32_bf16 v63, v33, v33
    v_dot2c_f32_bf16 v36, s31, v30
    v_dot2c_f32_bf16 v37, v30, v30
    v_dot2c_f32_bf16 v47, s31, v34
    v_dot2c_f32_bf16 v63, v34, v34
    v_dot2c_f32_bf16 v36, s31, v31
    v_dot2c_f32_bf16 v37, v31, v31
    v_dot2c_f32_bf16 v47, s31, v35
    v_dot2c_f32_bf16 v63, v35, v35
    v_mfma_f32_32x32x16_bf16 v[64:79], a[240:243], v[140:143], v[64:79]
    s_barrier
    ds_read_b128 v[144:147], v12 offset:16384
    ds_read_b64_tr_b16 a[224:225], v16 offset:16384
    ds_read_b64_tr_b16 a[226:227], v16 offset:17408
    s_lshr_b32 s99, s72, 1
    s_mul_i32 s24, s99, 49152
    s_add_u32 s24, s24, s98
    v_add_u32 v44, s15, v58
    v_mfma_f32_32x32x16_bf16 v[80:95], a[244:247], v[140:143], v[80:95]
    ds_read_b64_tr_b16 a[228:229], v17 offset:16384
    s_add_u32 m0, s79, 0
    ds_read_b64_tr_b16 a[230:231], v17 offset:17408
    buffer_load_dwordx4 v4, s[32:35], s85 offen offset:0 lds
    v_mfma_f32_32x32x16_bf16 v[96:111], a[248:251], v[140:143], v[96:111]
    ds_read_b64_tr_b16 a[232:233], v18 offset:16384
    ds_read_b64_tr_b16 a[234:235], v18 offset:17408
    buffer_load_dwordx4 v5, s[32:35], s85 offen offset:1024 lds
    v_mfma_f32_32x32x16_bf16 v[112:127], a[252:255], v[140:143], v[112:127]
    ds_read_b64_tr_b16 a[236:237], v19 offset:16384
    ds_read_b64_tr_b16 a[238:239], v19 offset:17408
    v_xor_b32 v45, 64, v44
    s_mov_b32 s80, 0xbdd2d3e8
    s_mov_b32 s81, 0xc0135761
    s_lshl_b32 s98, s76, 5
    s_lshl_b32 s99, s64, 11
    s_add_u32 s68, s99, s98
    s_lshl_b32 s99, s65, 11
    s_add_u32 s69, s99, s98
    s_lshl_b32 s99, s66, 11
    s_add_u32 s70, s99, s98
    s_lshl_b32 s99, s67, 11
    s_add_u32 s71, s99, s98
    s_cmp_eq_u32 s75, 3
    s_cselect_b32 s99, 0x200, 0
    v_mfma_f32_16x16x32_bf16 v[24:27], a[240:243], v[20:23], v[24:27]
    s_sub_u32 s99, 131072, s99
    v_lshl_add_u32 v58, v3, 4, s99
    v_lshl_add_u32 v49, s65, 9, v58
    v_lshl_add_u32 v50, s66, 9, v58
    v_lshl_add_u32 v51, s67, 9, v58
    s_waitcnt lgkmcnt(6)
    v_mfma_f32_32x32x16_bf16 v[64:79], a[224:227], v[144:147], v[64:79]
    ds_read_b128 v[148:151], v13 offset:16384
    ds_read_b64_tr_b16 a[240:241], v16 offset:20480
    ds_read_b64_tr_b16 a[242:243], v16 offset:21504
    s_lshl_b32 s99, s72, 9
    s_add_u32 s99, s99, 131072
    v_lshl_add_u32 v48, v3, 4, s99
    s_or_b32 s98, s73, s74
    s_cmp_eq_u32 s98, 0
    s_cselect_b32 s30, 0, 1073741824
    s_mul_i32 s98, s27, 114688
    s_waitcnt lgkmcnt(7)
    v_mfma_f32_32x32x16_bf16 v[80:95], a[228:231], v[144:147], v[80:95]
    ds_read_b64_tr_b16 a[244:245], v17 offset:20480
    s_add_u32 m0, s79, 0
    ds_read_b64_tr_b16 a[246:247], v17 offset:21504
    buffer_load_dwordx4 v6, s[32:35], s85 offen offset:2048 lds
    s_waitcnt lgkmcnt(7)
    v_mfma_f32_32x32x16_bf16 v[96:111], a[232:235], v[144:147], v[96:111]
    ds_read_b64_tr_b16 a[248:249], v18 offset:20480
    ds_read_b64_tr_b16 a[250:251], v18 offset:21504
    buffer_load_dwordx4 v7, s[32:35], s85 offen offset:3072 lds
    s_waitcnt lgkmcnt(7)
    v_mfma_f32_32x32x16_bf16 v[112:127], a[236:239], v[144:147], v[112:127]
    ds_read_b64_tr_b16 a[252:253], v19 offset:20480
    ds_read_b64_tr_b16 a[254:255], v19 offset:21504
    v_add_u32 v46, s98, v61
    v_and_b32 v58, 0x30, v0
    v_bfe_u32 v59, v0, 2, 1
    v_lshl_add_u32 v58, v59, 6, v58
    s_lshl_b32 s98, s72, 9
    s_add_u32 s98, s98, 131072
    v_add_u32 v60, s98, v58
    s_and_b32 s3, s72, 1
    s_lshl1_add_u32 s4, s78, s3
    s_lshl_b32 s4, s4, 5
    s_lshr_b32 s3, s72, 1
    s_lshl_b32 s3, s3, 5
    s_add_u32 s9, s3, s77
    s_lshl4_add_u32 s3, s27, s74
    s_lshl_b32 s3, s3, 6
    v_readfirstlane_b32 s25, v39
    v_permlane32_swap_b32 v36, v47
    v_permlane32_swap_b32 v37, v63
    v_mfma_f32_16x16x32_bf16 v[24:27], a[224:227], v[20:23], v[24:27]
    s_add_u32 s25, s25, 2654435769
    v_add_f32 v36, v36, v47
    v_add_f32 v37, v37, v63
    v_mov_b32 v29, s25
    v_add_f32_dpp v36, v36, v36 row_shr:1 row_mask:0xf bank_mask:0xf bound_ctrl:0
    v_add_f32_dpp v37, v37, v37 row_shr:1 row_mask:0xf bank_mask:0xf bound_ctrl:0
    s_waitcnt lgkmcnt(6)
    v_mfma_f32_32x32x16_bf16 v[64:79], a[240:243], v[148:151], v[64:79]
    ds_read_b128 v[152:155], v14 offset:16384
    ds_read_b64_tr_b16 a[224:225], v16 offset:24576
    ds_read_b64_tr_b16 a[226:227], v16 offset:25600
    s_add_u32 s48, s3, 7340032
    s_lshl_b32 s7, s72, 19
    s_lshl4_add_u32 s3, s73, s74
    s_lshl_b32 s3, s3, 8
    s_add_u32 s7, s7, s3
    s_add_u32 s7, s7, 8388608
    s_waitcnt lgkmcnt(7)
    v_mfma_f32_32x32x16_bf16 v[80:95], a[244:247], v[148:151], v[80:95]
    ds_read_b64_tr_b16 a[228:229], v17 offset:24576
    s_add_u32 m0, s79, 49152
    ds_read_b64_tr_b16 a[230:231], v17 offset:25600
    buffer_load_dwordx4 v8, s[36:39], s93 offen offset:0 lds
    s_waitcnt lgkmcnt(7)
    v_mfma_f32_32x32x16_bf16 v[96:111], a[248:251], v[148:151], v[96:111]
    ds_read_b64_tr_b16 a[232:233], v18 offset:24576
    ds_read_b64_tr_b16 a[234:235], v18 offset:25600
    buffer_load_dwordx4 v9, s[36:39], s93 offen offset:1024 lds
    s_waitcnt lgkmcnt(7)
    v_mfma_f32_32x32x16_bf16 v[112:127], a[252:255], v[148:151], v[112:127]
    ds_read_b64_tr_b16 a[236:237], v19 offset:24576
    ds_read_b64_tr_b16 a[238:239], v19 offset:25600
    s_lshl2_add_u32 s3, s74, s72
    s_lshl4_add_u32 s3, s3, s73
    s_lshl_b32 s3, s3, 6
    s_add_u32 s8, s3, 7405568
    s_lshl2_add_u32 s3, s77, s72
    s_lshl_b32 s3, s3, 8
    s_add_u32 s49, s3, 7340032
    s_mul_i32 s3, s72, 28672
    s_mul_i32 s50, s9, 114688
    s_add_u32 s50, s50, s3
    s_xor_b32 s51, s9, 32
    s_mul_i32 s51, s51, 114688
    s_add_u32 s51, s51, s3
    s_sub_u32 s3, 32, s77
    s_and_b32 s3, s3, 31
    s_cmp_ge_u32 s78, 4
    s_cselect_b32 s6, s3, s77
    s_cselect_b32 s5, 1, 0
    v_mov_b32 v31, s25
    v_add_f32_dpp v36, v36, v36 row_shr:2 row_mask:0xf bank_mask:0xf bound_ctrl:0
    v_mfma_f32_16x16x32_bf16 v[24:27], a[240:243], v[20:23], v[24:27]
    v_add_f32_dpp v37, v37, v37 row_shr:2 row_mask:0xf bank_mask:0xf bound_ctrl:0
    v_lshlrev_b32 v32, 4, v3
    v_add_f32_dpp v36, v36, v36 row_shr:4 row_mask:0xf bank_mask:0xf bound_ctrl:0
    v_add_f32_dpp v37, v37, v37 row_shr:4 row_mask:0xf bank_mask:0xf bound_ctrl:0
    s_lshl4_add_u32 s26, s14, s74
    v_add_f32_dpp v36, v36, v36 row_shr:8 row_mask:0xf bank_mask:0xf bound_ctrl:0
    v_add_f32_dpp v37, v37, v37 row_shr:8 row_mask:0xf bank_mask:0xf bound_ctrl:0
    s_waitcnt lgkmcnt(6)
    v_mfma_f32_32x32x16_bf16 v[64:79], a[224:227], v[152:155], v[64:79]
    ds_read_b128 v[156:159], v15 offset:16384
    ds_read_b64_tr_b16 a[240:241], v16 offset:28672
    ds_read_b64_tr_b16 a[242:243], v16 offset:29696
    s_lshl_b32 s26, s26, 5
    s_waitcnt lgkmcnt(7)
    v_mfma_f32_32x32x16_bf16 v[80:95], a[228:231], v[152:155], v[80:95]
    ds_read_b64_tr_b16 a[244:245], v17 offset:28672
    s_add_u32 m0, s79, 49152
    ds_read_b64_tr_b16 a[246:247], v17 offset:29696
    buffer_load_dwordx4 v10, s[36:39], s93 offen offset:2048 lds
    s_waitcnt lgkmcnt(7)
    v_mfma_f32_32x32x16_bf16 v[96:111], a[232:235], v[152:155], v[96:111]
    ds_read_b64_tr_b16 a[248:249], v18 offset:28672
    ds_read_b64_tr_b16 a[250:251], v18 offset:29696
    buffer_load_dwordx4 v11, s[36:39], s93 offen offset:3072 lds
    s_waitcnt lgkmcnt(7)
    v_mfma_f32_32x32x16_bf16 v[112:127], a[236:239], v[152:155], v[112:127]
    ds_read_b64_tr_b16 a[252:253], v19 offset:28672
    ds_read_b64_tr_b16 a[254:255], v19 offset:29696
    v_add_f32_dpp v36, v36, v36 row_bcast:15 row_mask:0xa bank_mask:0xf
    v_add_f32_dpp v37, v37, v37 row_bcast:15 row_mask:0xa bank_mask:0xf
    s_add_u32 s26, s26, 7602176
    v_mul_f32 v28, 0x3b000000, v36
    v_mul_f32 v37, 0x3b000000, v37
    v_fma_f32 v30, -v28, v28, v37
    v_mfma_f32_16x16x32_bf16 v[24:27], a[224:227], v[20:23], v[24:27]
    v_max_f32 v30, 0, v30
    s_mov_b32 exec_lo, 0x80000000
    s_mov_b32 exec_hi, 0x80000000
    buffer_store_dwordx4 v[28:31], v32, s[44:47], s26 offen sc1
    s_mov_b64 exec, -1
    s_waitcnt lgkmcnt(0)
    v_mfma_f32_32x32x16_bf16 v[64:79], a[240:243], v[156:159], v[64:79]
    s_waitcnt vmcnt(9)
    s_barrier
    ds_read_b128 v[160:163], v12 offset:32768
    ds_read_b64_tr_b16 a[224:225], v16 offset:32768
    ds_read_b64_tr_b16 a[226:227], v16 offset:33792
    v_mfma_f32_32x32x16_bf16 v[80:95], a[244:247], v[156:159], v[80:95]
    ds_read_b64_tr_b16 a[228:229], v17 offset:32768
    s_add_u32 m0, s79, 16384
    ds_read_b64_tr_b16 a[230:231], v17 offset:33792
    buffer_load_dwordx4 v4, s[32:35], s86 offen offset:0 lds
    v_mfma_f32_32x32x16_bf16 v[96:111], a[248:251], v[156:159], v[96:111]
    ds_read_b64_tr_b16 a[232:233], v18 offset:32768
    ds_read_b64_tr_b16 a[234:235], v18 offset:33792
    buffer_load_dwordx4 v5, s[32:35], s86 offen offset:1024 lds
    v_mfma_f32_32x32x16_bf16 v[112:127], a[252:255], v[156:159], v[112:127]
    ds_read_b64_tr_b16 a[236:237], v19 offset:32768
    ds_read_b64_tr_b16 a[238:239], v19 offset:33792
    v_mfma_f32_16x16x32_bf16 v[24:27], a[240:243], v[20:23], v[24:27]
    s_waitcnt lgkmcnt(6)
    v_mfma_f32_32x32x16_bf16 v[64:79], a[224:227], v[160:163], v[64:79]
    ds_read_b128 v[164:167], v13 offset:32768
    ds_read_b64_tr_b16 a[240:241], v16 offset:36864
    ds_read_b64_tr_b16 a[242:243], v16 offset:37888
    s_waitcnt lgkmcnt(7)
    v_mfma_f32_32x32x16_bf16 v[80:95], a[228:231], v[160:163], v[80:95]
    ds_read_b64_tr_b16 a[244:245], v17 offset:36864
    s_add_u32 m0, s79, 16384
    ds_read_b64_tr_b16 a[246:247], v17 offset:37888
    buffer_load_dwordx4 v6, s[32:35], s86 offen offset:2048 lds
    s_waitcnt lgkmcnt(7)
    v_mfma_f32_32x32x16_bf16 v[96:111], a[232:235], v[160:163], v[96:111]
    ds_read_b64_tr_b16 a[248:249], v18 offset:36864
    ds_read_b64_tr_b16 a[250:251], v18 offset:37888
    buffer_load_dwordx4 v7, s[32:35], s86 offen offset:3072 lds
    s_waitcnt lgkmcnt(7)
    v_mfma_f32_32x32x16_bf16 v[112:127], a[236:239], v[160:163], v[112:127]
    ds_read_b64_tr_b16 a[252:253], v19 offset:36864
    ds_read_b64_tr_b16 a[254:255], v19 offset:37888
    v_mfma_f32_16x16x32_bf16 v[24:27], a[224:227], v[20:23], v[24:27]
    s_waitcnt lgkmcnt(6)
    v_mfma_f32_32x32x16_bf16 v[64:79], a[240:243], v[164:167], v[64:79]
    ds_read_b128 v[168:171], v14 offset:32768
    ds_read_b64_tr_b16 a[224:225], v16 offset:40960
    ds_read_b64_tr_b16 a[226:227], v16 offset:41984
    s_waitcnt lgkmcnt(7)
    v_mfma_f32_32x32x16_bf16 v[80:95], a[244:247], v[164:167], v[80:95]
    ds_read_b64_tr_b16 a[228:229], v17 offset:40960
    s_add_u32 m0, s79, 65536
    ds_read_b64_tr_b16 a[230:231], v17 offset:41984
    buffer_load_dwordx4 v8, s[36:39], s94 offen offset:0 lds
    s_waitcnt lgkmcnt(7)
    v_mfma_f32_32x32x16_bf16 v[96:111], a[248:251], v[164:167], v[96:111]
    ds_read_b64_tr_b16 a[232:233], v18 offset:40960
    ds_read_b64_tr_b16 a[234:235], v18 offset:41984
    buffer_load_dwordx4 v9, s[36:39], s94 offen offset:1024 lds
    s_waitcnt lgkmcnt(7)
    v_mfma_f32_32x32x16_bf16 v[112:127], a[252:255], v[164:167], v[112:127]
    ds_read_b64_tr_b16 a[236:237], v19 offset:40960
    ds_read_b64_tr_b16 a[238:239], v19 offset:41984
    v_mfma_f32_16x16x32_bf16 v[24:27], a[240:243], v[20:23], v[24:27]
    s_waitcnt lgkmcnt(6)
    v_mfma_f32_32x32x16_bf16 v[64:79], a[224:227], v[168:171], v[64:79]
    ds_read_b128 v[172:175], v15 offset:32768
    ds_read_b64_tr_b16 a[240:241], v16 offset:45056
    ds_read_b64_tr_b16 a[242:243], v16 offset:46080
    s_waitcnt lgkmcnt(7)
    v_mfma_f32_32x32x16_bf16 v[80:95], a[228:231], v[168:171], v[80:95]
    ds_read_b64_tr_b16 a[244:245], v17 offset:45056
    s_add_u32 m0, s79, 65536
    ds_read_b64_tr_b16 a[246:247], v17 offset:46080
    buffer_load_dwordx4 v10, s[36:39], s94 offen offset:2048 lds
    s_waitcnt lgkmcnt(7)
    v_mfma_f32_32x32x16_bf16 v[96:111], a[232:235], v[168:171], v[96:111]
    ds_read_b64_tr_b16 a[248:249], v18 offset:45056
    ds_read_b64_tr_b16 a[250:251], v18 offset:46080
    buffer_load_dwordx4 v11, s[36:39], s94 offen offset:3072 lds
    s_waitcnt lgkmcnt(7)
    v_mfma_f32_32x32x16_bf16 v[112:127], a[236:239], v[168:171], v[112:127]
    ds_read_b64_tr_b16 a[252:253], v19 offset:45056
    ds_read_b64_tr_b16 a[254:255], v19 offset:46080
    v_mfma_f32_16x16x32_bf16 v[24:27], a[224:227], v[20:23], v[24:27]
    s_waitcnt lgkmcnt(0)
    v_mfma_f32_32x32x16_bf16 v[64:79], a[240:243], v[172:175], v[64:79]
    s_waitcnt vmcnt(9)
    s_barrier
    ds_read_b128 v[176:179], v12 offset:0
    ds_read_b64_tr_b16 a[224:225], v16 offset:0
    ds_read_b64_tr_b16 a[226:227], v16 offset:1024
    v_mfma_f32_32x32x16_bf16 v[80:95], a[244:247], v[172:175], v[80:95]
    ds_read_b64_tr_b16 a[228:229], v17 offset:0
    s_add_u32 m0, s79, 32768
    ds_read_b64_tr_b16 a[230:231], v17 offset:1024
    buffer_load_dwordx4 v4, s[32:35], s87 offen offset:0 lds
    v_mfma_f32_32x32x16_bf16 v[96:111], a[248:251], v[172:175], v[96:111]
    ds_read_b64_tr_b16 a[232:233], v18 offset:0
    ds_read_b64_tr_b16 a[234:235], v18 offset:1024
    buffer_load_dwordx4 v5, s[32:35], s87 offen offset:1024 lds
    v_mfma_f32_32x32x16_bf16 v[112:127], a[252:255], v[172:175], v[112:127]
    ds_read_b64_tr_b16 a[236:237], v19 offset:0
    ds_read_b64_tr_b16 a[238:239], v19 offset:1024
    v_mfma_f32_16x16x32_bf16 v[24:27], a[240:243], v[20:23], v[24:27]
    s_waitcnt lgkmcnt(6)
    v_mfma_f32_32x32x16_bf16 v[64:79], a[224:227], v[176:179], v[64:79]
    ds_read_b128 v[180:183], v13 offset:0
    ds_read_b64_tr_b16 a[240:241], v16 offset:4096
    ds_read_b64_tr_b16 a[242:243], v16 offset:5120
    s_waitcnt lgkmcnt(7)
    v_mfma_f32_32x32x16_bf16 v[80:95], a[228:231], v[176:179], v[80:95]
    ds_read_b64_tr_b16 a[244:245], v17 offset:4096
    s_add_u32 m0, s79, 32768
    ds_read_b64_tr_b16 a[246:247], v17 offset:5120
    buffer_load_dwordx4 v6, s[32:35], s87 offen offset:2048 lds
    s_waitcnt lgkmcnt(7)
    v_mfma_f32_32x32x16_bf16 v[96:111], a[232:235], v[176:179], v[96:111]
    ds_read_b64_tr_b16 a[248:249], v18 offset:4096
    ds_read_b64_tr_b16 a[250:251], v18 offset:5120
    buffer_load_dwordx4 v7, s[32:35], s87 offen offset:3072 lds
    s_waitcnt lgkmcnt(7)
    v_mfma_f32_32x32x16_bf16 v[112:127], a[236:239], v[176:179], v[112:127]
    ds_read_b64_tr_b16 a[252:253], v19 offset:4096
    ds_read_b64_tr_b16 a[254:255], v19 offset:5120
    v_mfma_f32_16x16x32_bf16 v[24:27], a[224:227], v[20:23], v[24:27]
    s_waitcnt lgkmcnt(6)
    v_mfma_f32_32x32x16_bf16 v[64:79], a[240:243], v[180:183], v[64:79]
    ds_read_b128 v[184:187], v14 offset:0
    ds_read_b64_tr_b16 a[224:225], v16 offset:8192
    ds_read_b64_tr_b16 a[226:227], v16 offset:9216
    s_waitcnt lgkmcnt(7)
    v_mfma_f32_32x32x16_bf16 v[80:95], a[244:247], v[180:183], v[80:95]
    ds_read_b64_tr_b16 a[228:229], v17 offset:8192
    s_add_u32 m0, s79, 81920
    ds_read_b64_tr_b16 a[230:231], v17 offset:9216
    buffer_load_dwordx4 v8, s[36:39], s95 offen offset:0 lds
    s_waitcnt lgkmcnt(7)
    v_mfma_f32_32x32x16_bf16 v[96:111], a[248:251], v[180:183], v[96:111]
    ds_read_b64_tr_b16 a[232:233], v18 offset:8192
    ds_read_b64_tr_b16 a[234:235], v18 offset:9216
    buffer_load_dwordx4 v9, s[36:39], s95 offen offset:1024 lds
    s_waitcnt lgkmcnt(7)
    v_mfma_f32_32x32x16_bf16 v[112:127], a[252:255], v[180:183], v[112:127]
    ds_read_b64_tr_b16 a[236:237], v19 offset:8192
    ds_read_b64_tr_b16 a[238:239], v19 offset:9216
    v_mfma_f32_16x16x32_bf16 v[24:27], a[240:243], v[20:23], v[24:27]
    s_waitcnt lgkmcnt(6)
    v_mfma_f32_32x32x16_bf16 v[64:79], a[224:227], v[184:187], v[64:79]
    ds_read_b128 v[188:191], v15 offset:0
    ds_read_b64_tr_b16 a[240:241], v16 offset:12288
    ds_read_b64_tr_b16 a[242:243], v16 offset:13312
    s_waitcnt lgkmcnt(7)
    v_mfma_f32_32x32x16_bf16 v[80:95], a[228:231], v[184:187], v[80:95]
    ds_read_b64_tr_b16 a[244:245], v17 offset:12288
    s_add_u32 m0, s79, 81920
    ds_read_b64_tr_b16 a[246:247], v17 offset:13312
    buffer_load_dwordx4 v10, s[36:39], s95 offen offset:2048 lds
    s_waitcnt lgkmcnt(7)
    v_mfma_f32_32x32x16_bf16 v[96:111], a[232:235], v[184:187], v[96:111]
    ds_read_b64_tr_b16 a[248:249], v18 offset:12288
    ds_read_b64_tr_b16 a[250:251], v18 offset:13312
    buffer_load_dwordx4 v11, s[36:39], s95 offen offset:3072 lds
    s_waitcnt lgkmcnt(7)
    v_mfma_f32_32x32x16_bf16 v[112:127], a[236:239], v[184:187], v[112:127]
    ds_read_b64_tr_b16 a[252:253], v19 offset:12288
    ds_read_b64_tr_b16 a[254:255], v19 offset:13312
    v_mfma_f32_16x16x32_bf16 v[24:27], a[224:227], v[20:23], v[24:27]
    s_waitcnt lgkmcnt(0)
    v_mfma_f32_32x32x16_bf16 v[64:79], a[240:243], v[188:191], v[64:79]
    s_waitcnt vmcnt(8)
    s_barrier
    ds_read_b128 v[192:195], v12 offset:16384
    ds_read_b64_tr_b16 a[224:225], v16 offset:16384
    ds_read_b64_tr_b16 a[226:227], v16 offset:17408
    v_lshlrev_b32 v2, 16, v38
    v_and_b32 v1, 31, v0
    v_mfma_f32_32x32x16_bf16 v[80:95], a[244:247], v[188:191], v[80:95]
    ds_read_b64_tr_b16 a[228:229], v17 offset:16384
    s_add_u32 m0, s79, 0
    ds_read_b64_tr_b16 a[230:231], v17 offset:17408
    buffer_load_dwordx4 v4, s[32:35], s88 offen offset:0 lds
    v_mfma_f32_32x32x16_bf16 v[96:111], a[248:251], v[188:191], v[96:111]
    ds_read_b64_tr_b16 a[232:233], v18 offset:16384
    ds_read_b64_tr_b16 a[234:235], v18 offset:17408
    buffer_load_dwordx4 v5, s[32:35], s88 offen offset:1024 lds
    v_mfma_f32_32x32x16_bf16 v[112:127], a[252:255], v[188:191], v[112:127]
    ds_read_b64_tr_b16 a[236:237], v19 offset:16384
    ds_read_b64_tr_b16 a[238:239], v19 offset:17408
    s_lshl_b32 s98, s72, 9
    s_add_u32 s98, s98, 131072
    v_lshl_add_u32 v38, v1, 2, s98
    ds_write_b32 v38, v2 offset:128
    v_lshlrev_b32 v53, 16, v53
    s_lshl_b32 s98, s72, 7
    v_mfma_f32_16x16x32_bf16 v[24:27], a[240:243], v[20:23], v[24:27]
    s_add_u32 s98, s98, 137216
    v_lshl_add_u32 v1, v1, 2, s98
    ds_write_b32 v1, v53
    s_waitcnt lgkmcnt(8)
    v_mfma_f32_32x32x16_bf16 v[64:79], a[224:227], v[192:195], v[64:79]
    ds_read_b128 v[196:199], v13 offset:16384
    ds_read_b64_tr_b16 a[240:241], v16 offset:20480
    ds_read_b64_tr_b16 a[242:243], v16 offset:21504
    s_lshl_b32 s82, s72, 9
    s_waitcnt lgkmcnt(9)
    v_mfma_f32_32x32x16_bf16 v[80:95], a[228:231], v[192:195], v[80:95]
    ds_read_b64_tr_b16 a[244:245], v17 offset:20480
    s_add_u32 m0, s79, 0
    ds_read_b64_tr_b16 a[246:247], v17 offset:21504
    buffer_load_dwordx4 v6, s[32:35], s88 offen offset:2048 lds
    s_waitcnt lgkmcnt(9)
    v_mfma_f32_32x32x16_bf16 v[96:111], a[232:235], v[192:195], v[96:111]
    ds_read_b64_tr_b16 a[248:249], v18 offset:20480
    ds_read_b64_tr_b16 a[250:251], v18 offset:21504
    buffer_load_dwordx4 v7, s[32:35], s88 offen offset:3072 lds
    s_waitcnt lgkmcnt(9)
    v_mfma_f32_32x32x16_bf16 v[112:127], a[236:239], v[192:195], v[112:127]
    ds_read_b64_tr_b16 a[252:253], v19 offset:20480
    ds_read_b64_tr_b16 a[254:255], v19 offset:21504
    s_add_u32 s82, s82, 131328
    s_lshl2_add_u32 s83, s72, 139264
    s_lshl_b32 s84, s72, 11
    v_mfma_f32_16x16x32_bf16 v[24:27], a[224:227], v[20:23], v[24:27]
    s_add_u32 s84, s84, 139264
    s_lshl_b32 s85, s4, 1
    s_waitcnt lgkmcnt(6)
    v_mfma_f32_32x32x16_bf16 v[64:79], a[240:243], v[196:199], v[64:79]
    ds_read_b128 v[200:203], v14 offset:16384
    ds_read_b64_tr_b16 a[224:225], v16 offset:24576
    ds_read_b64_tr_b16 a[226:227], v16 offset:25600
    v_and_b32 v47, 31, v0
    s_waitcnt lgkmcnt(7)
    v_mfma_f32_32x32x16_bf16 v[80:95], a[244:247], v[196:199], v[80:95]
    ds_read_b64_tr_b16 a[228:229], v17 offset:24576
    s_add_u32 m0, s79, 49152
    ds_read_b64_tr_b16 a[230:231], v17 offset:25600
    buffer_load_dwordx4 v8, s[36:39], s96 offen offset:0 lds
    s_waitcnt lgkmcnt(7)
    v_mfma_f32_32x32x16_bf16 v[96:111], a[248:251], v[196:199], v[96:111]
    ds_read_b64_tr_b16 a[232:233], v18 offset:24576
    ds_read_b64_tr_b16 a[234:235], v18 offset:25600
    buffer_load_dwordx4 v9, s[36:39], s96 offen offset:1024 lds
    s_waitcnt lgkmcnt(7)
    v_mfma_f32_32x32x16_bf16 v[112:127], a[252:255], v[196:199], v[112:127]
    ds_read_b64_tr_b16 a[236:237], v19 offset:24576
    ds_read_b64_tr_b16 a[238:239], v19 offset:25600
    v_lshl_add_u32 v47, v47, 6, s9
    v_lshl_add_u32 v39, v47, 10, s85
    v_lshlrev_b32 v47, 4, v3
    v_mfma_f32_16x16x32_bf16 v[24:27], a[240:243], v[20:23], v[24:27]
    v_add_u32 v39, v47, v39
    s_waitcnt lgkmcnt(6)
    v_mfma_f32_32x32x16_bf16 v[64:79], a[224:227], v[200:203], v[64:79]
    ds_read_b128 v[204:207], v15 offset:16384
    ds_read_b64_tr_b16 a[240:241], v16 offset:28672
    ds_read_b64_tr_b16 a[242:243], v16 offset:29696
    s_waitcnt lgkmcnt(7)
    v_mfma_f32_32x32x16_bf16 v[80:95], a[228:231], v[200:203], v[80:95]
    ds_read_b64_tr_b16 a[244:245], v17 offset:28672
    s_add_u32 m0, s79, 49152
    ds_read_b64_tr_b16 a[246:247], v17 offset:29696
    buffer_load_dwordx4 v10, s[36:39], s96 offen offset:2048 lds
    s_waitcnt lgkmcnt(7)
    v_mfma_f32_32x32x16_bf16 v[96:111], a[232:235], v[200:203], v[96:111]
    ds_read_b64_tr_b16 a[248:249], v18 offset:28672
    ds_read_b64_tr_b16 a[250:251], v18 offset:29696
    buffer_load_dwordx4 v11, s[36:39], s96 offen offset:3072 lds
    s_waitcnt lgkmcnt(7)
    v_mfma_f32_32x32x16_bf16 v[112:127], a[236:239], v[200:203], v[112:127]
    ds_read_b64_tr_b16 a[252:253], v19 offset:28672
    ds_read_b64_tr_b16 a[254:255], v19 offset:29696
    v_mfma_f32_16x16x32_bf16 v[24:27], a[224:227], v[20:23], v[24:27]
    s_waitcnt lgkmcnt(0)
    v_mfma_f32_32x32x16_bf16 v[64:79], a[240:243], v[204:207], v[64:79]
    s_waitcnt vmcnt(8)
    s_barrier
    ds_read_b128 v[208:211], v12 offset:32768
    ds_read_b64_tr_b16 a[224:225], v16 offset:32768
    ds_read_b64_tr_b16 a[226:227], v16 offset:33792
    v_mfma_f32_32x32x16_bf16 v[80:95], a[244:247], v[204:207], v[80:95]
    ds_read_b64_tr_b16 a[228:229], v17 offset:32768
    s_add_u32 m0, s79, 16384
    ds_read_b64_tr_b16 a[230:231], v17 offset:33792
    buffer_load_dwordx4 v4, s[32:35], s89 offen offset:0 lds
    v_mfma_f32_32x32x16_bf16 v[96:111], a[248:251], v[204:207], v[96:111]
    ds_read_b64_tr_b16 a[232:233], v18 offset:32768
    ds_read_b64_tr_b16 a[234:235], v18 offset:33792
    buffer_load_dwordx4 v5, s[32:35], s89 offen offset:1024 lds
    v_mfma_f32_32x32x16_bf16 v[112:127], a[252:255], v[204:207], v[112:127]
    ds_read_b64_tr_b16 a[236:237], v19 offset:32768
    ds_read_b64_tr_b16 a[238:239], v19 offset:33792
    v_mfma_f32_16x16x32_bf16 v[24:27], a[240:243], v[20:23], v[24:27]
    s_waitcnt lgkmcnt(6)
    v_mfma_f32_32x32x16_bf16 v[64:79], a[224:227], v[208:211], v[64:79]
    ds_read_b128 v[212:215], v13 offset:32768
    ds_read_b64_tr_b16 a[240:241], v16 offset:36864
    ds_read_b64_tr_b16 a[242:243], v16 offset:37888
    s_waitcnt lgkmcnt(7)
    v_mfma_f32_32x32x16_bf16 v[80:95], a[228:231], v[208:211], v[80:95]
    ds_read_b64_tr_b16 a[244:245], v17 offset:36864
    s_add_u32 m0, s79, 16384
    ds_read_b64_tr_b16 a[246:247], v17 offset:37888
    buffer_load_dwordx4 v6, s[32:35], s89 offen offset:2048 lds
    s_waitcnt lgkmcnt(7)
    v_mfma_f32_32x32x16_bf16 v[96:111], a[232:235], v[208:211], v[96:111]
    ds_read_b64_tr_b16 a[248:249], v18 offset:36864
    ds_read_b64_tr_b16 a[250:251], v18 offset:37888
    buffer_load_dwordx4 v7, s[32:35], s89 offen offset:3072 lds
    s_waitcnt lgkmcnt(7)
    v_mfma_f32_32x32x16_bf16 v[112:127], a[236:239], v[208:211], v[112:127]
    ds_read_b64_tr_b16 a[252:253], v19 offset:36864
    ds_read_b64_tr_b16 a[254:255], v19 offset:37888
    v_mfma_f32_16x16x32_bf16 v[24:27], a[224:227], v[20:23], v[24:27]
    s_waitcnt lgkmcnt(6)
    v_mfma_f32_32x32x16_bf16 v[64:79], a[240:243], v[212:215], v[64:79]
    ds_read_b128 v[216:219], v14 offset:32768
    ds_read_b64_tr_b16 a[224:225], v16 offset:40960
    ds_read_b64_tr_b16 a[226:227], v16 offset:41984
    s_waitcnt lgkmcnt(7)
    v_mfma_f32_32x32x16_bf16 v[80:95], a[244:247], v[212:215], v[80:95]
    ds_read_b64_tr_b16 a[228:229], v17 offset:40960
    s_add_u32 m0, s79, 65536
    ds_read_b64_tr_b16 a[230:231], v17 offset:41984
    buffer_load_dwordx4 v8, s[36:39], s97 offen offset:0 lds
    s_waitcnt lgkmcnt(7)
    v_mfma_f32_32x32x16_bf16 v[96:111], a[248:251], v[212:215], v[96:111]
    ds_read_b64_tr_b16 a[232:233], v18 offset:40960
    ds_read_b64_tr_b16 a[234:235], v18 offset:41984
    buffer_load_dwordx4 v9, s[36:39], s97 offen offset:1024 lds
    s_waitcnt lgkmcnt(7)
    v_mfma_f32_32x32x16_bf16 v[112:127], a[252:255], v[212:215], v[112:127]
    ds_read_b64_tr_b16 a[236:237], v19 offset:40960
    ds_read_b64_tr_b16 a[238:239], v19 offset:41984
    v_mfma_f32_16x16x32_bf16 v[24:27], a[240:243], v[20:23], v[24:27]
    s_waitcnt lgkmcnt(6)
    v_mfma_f32_32x32x16_bf16 v[64:79], a[224:227], v[216:219], v[64:79]
    ds_read_b128 v[220:223], v15 offset:32768
    ds_read_b64_tr_b16 a[240:241], v16 offset:45056
    ds_read_b64_tr_b16 a[242:243], v16 offset:46080
    v_and_b32 v32, 31, v0
    s_waitcnt lgkmcnt(7)
    v_mfma_f32_32x32x16_bf16 v[80:95], a[228:231], v[216:219], v[80:95]
    ds_read_b64_tr_b16 a[244:245], v17 offset:45056
    s_add_u32 m0, s79, 65536
    ds_read_b64_tr_b16 a[246:247], v17 offset:46080
    buffer_load_dwordx4 v10, s[36:39], s97 offen offset:2048 lds
    s_waitcnt lgkmcnt(7)
    v_mfma_f32_32x32x16_bf16 v[96:111], a[232:235], v[216:219], v[96:111]
    ds_read_b64_tr_b16 a[248:249], v18 offset:45056
    ds_read_b64_tr_b16 a[250:251], v18 offset:46080
    buffer_load_dwordx4 v11, s[36:39], s97 offen offset:3072 lds
    s_waitcnt lgkmcnt(7)
    v_mfma_f32_32x32x16_bf16 v[112:127], a[236:239], v[216:219], v[112:127]
    ds_read_b64_tr_b16 a[252:253], v19 offset:45056
    ds_read_b64_tr_b16 a[254:255], v19 offset:46080
    v_lshlrev_b32 v32, 4, v32
    s_lshl_b32 s26, s14, 9
    s_add_u32 s26, s26, 7602176
    v_mfma_f32_16x16x32_bf16 v[24:27], a[224:227], v[20:23], v[24:27]
    buffer_load_dwordx4 v[28:31], v32, s[44:47], s26 offen sc1
    s_waitcnt lgkmcnt(0)
    v_mfma_f32_32x32x16_bf16 v[64:79], a[240:243], v[220:223], v[64:79]
    s_waitcnt vmcnt(9)
    s_barrier
    ds_read_b128 v[224:227], v12 offset:0
    ds_read_b64_tr_b16 a[224:225], v16 offset:0
    ds_read_b64_tr_b16 a[226:227], v16 offset:1024
    v_mfma_f32_32x32x16_bf16 v[80:95], a[244:247], v[220:223], v[80:95]
    ds_read_b64_tr_b16 a[228:229], v17 offset:0
    ds_read_b64_tr_b16 a[230:231], v17 offset:1024
    s_add_u32 m0, s15, 0
    s_lshl4_add_u32 s12, s16, s23
    buffer_load_dwordx4 v40, s[40:43], s12 offen offset:0 lds
    v_mfma_f32_32x32x16_bf16 v[96:111], a[248:251], v[220:223], v[96:111]
    ds_read_b64_tr_b16 a[232:233], v18 offset:0
    ds_read_b64_tr_b16 a[234:235], v18 offset:1024
    buffer_load_dwordx4 v41, s[40:43], s12 offen offset:1024 lds
    v_mfma_f32_32x32x16_bf16 v[112:127], a[252:255], v[220:223], v[112:127]
    ds_read_b64_tr_b16 a[236:237], v19 offset:0
    ds_read_b64_tr_b16 a[238:239], v19 offset:1024
    v_mfma_f32_16x16x32_bf16 v[24:27], a[240:243], v[20:23], v[24:27]
    s_waitcnt lgkmcnt(6)
    v_mfma_f32_32x32x16_bf16 v[64:79], a[224:227], v[224:227], v[64:79]
    ds_read_b128 v[228:231], v13 offset:0
    ds_read_b64_tr_b16 a[240:241], v16 offset:4096
    ds_read_b64_tr_b16 a[242:243], v16 offset:5120
    s_waitcnt lgkmcnt(7)
    v_mfma_f32_32x32x16_bf16 v[80:95], a[228:231], v[224:227], v[80:95]
    ds_read_b64_tr_b16 a[244:245], v17 offset:4096
    ds_read_b64_tr_b16 a[246:247], v17 offset:5120
    buffer_load_dwordx4 v42, s[40:43], s12 offen offset:2048 lds
    s_waitcnt lgkmcnt(7)
    v_mfma_f32_32x32x16_bf16 v[96:111], a[232:235], v[224:227], v[96:111]
    ds_read_b64_tr_b16 a[248:249], v18 offset:4096
    ds_read_b64_tr_b16 a[250:251], v18 offset:5120
    s_waitcnt lgkmcnt(7)
    v_mfma_f32_32x32x16_bf16 v[112:127], a[236:239], v[224:227], v[112:127]
    ds_read_b64_tr_b16 a[252:253], v19 offset:4096
    ds_read_b64_tr_b16 a[254:255], v19 offset:5120
    v_mfma_f32_16x16x32_bf16 v[24:27], a[224:227], v[20:23], v[24:27]
    s_waitcnt lgkmcnt(6)
    v_mfma_f32_32x32x16_bf16 v[64:79], a[240:243], v[228:231], v[64:79]
    ds_read_b128 v[232:235], v14 offset:0
    ds_read_b64_tr_b16 a[224:225], v16 offset:8192
    ds_read_b64_tr_b16 a[226:227], v16 offset:9216
    s_waitcnt lgkmcnt(7)
    v_mfma_f32_32x32x16_bf16 v[80:95], a[244:247], v[228:231], v[80:95]
    ds_read_b64_tr_b16 a[228:229], v17 offset:8192
    ds_read_b64_tr_b16 a[230:231], v17 offset:9216
    buffer_load_dwordx4 v43, s[40:43], s12 offen offset:3072 lds
    s_add_u32 m0, s15, 4096
    s_add_u32 s12, s12, 0x8000
    s_waitcnt lgkmcnt(7)
    v_mfma_f32_32x32x16_bf16 v[96:111], a[248:251], v[228:231], v[96:111]
    ds_read_b64_tr_b16 a[232:233], v18 offset:8192
    ds_read_b64_tr_b16 a[234:235], v18 offset:9216
    buffer_load_dwordx4 v40, s[40:43], s12 offen offset:0 lds
    s_waitcnt lgkmcnt(7)
    v_mfma_f32_32x32x16_bf16 v[112:127], a[252:255], v[228:231], v[112:127]
    ds_read_b64_tr_b16 a[236:237], v19 offset:8192
    ds_read_b64_tr_b16 a[238:239], v19 offset:9216
    v_mfma_f32_16x16x32_bf16 v[24:27], a[240:243], v[20:23], v[24:27]
    s_waitcnt lgkmcnt(6)
    v_mfma_f32_32x32x16_bf16 v[64:79], a[224:227], v[232:235], v[64:79]
    ds_read_b128 v[236:239], v15 offset:0
    ds_read_b64_tr_b16 a[240:241], v16 offset:12288
    ds_read_b64_tr_b16 a[242:243], v16 offset:13312
    s_waitcnt lgkmcnt(7)
    v_mfma_f32_32x32x16_bf16 v[80:95], a[228:231], v[232:235], v[80:95]
    ds_read_b64_tr_b16 a[244:245], v17 offset:12288
    ds_read_b64_tr_b16 a[246:247], v17 offset:13312
    buffer_load_dwordx4 v41, s[40:43], s12 offen offset:1024 lds
    s_waitcnt lgkmcnt(7)
    v_mfma_f32_32x32x16_bf16 v[96:111], a[232:235], v[232:235], v[96:111]
    ds_read_b64_tr_b16 a[248:249], v18 offset:12288
    ds_read_b64_tr_b16 a[250:251], v18 offset:13312
    s_waitcnt lgkmcnt(7)
    v_mfma_f32_32x32x16_bf16 v[112:127], a[236:239], v[232:235], v[112:127]
    ds_read_b64_tr_b16 a[252:253], v19 offset:12288
    ds_read_b64_tr_b16 a[254:255], v19 offset:13312
    v_mfma_f32_16x16x32_bf16 v[24:27], a[224:227], v[20:23], v[24:27]
    s_waitcnt lgkmcnt(0)
    v_mfma_f32_32x32x16_bf16 v[64:79], a[240:243], v[236:239], v[64:79]
    s_waitcnt vmcnt(7)
    s_barrier
    ds_read_b128 v[240:243], v12 offset:16384
    ds_read_b64_tr_b16 a[224:225], v16 offset:16384
    ds_read_b64_tr_b16 a[226:227], v16 offset:17408
    v_mfma_f32_32x32x16_bf16 v[80:95], a[244:247], v[236:239], v[80:95]
    ds_read_b64_tr_b16 a[228:229], v17 offset:16384
    ds_read_b64_tr_b16 a[230:231], v17 offset:17408
    buffer_load_dwordx4 v42, s[40:43], s12 offen offset:2048 lds
    v_mfma_f32_32x32x16_bf16 v[96:111], a[248:251], v[236:239], v[96:111]
    ds_read_b64_tr_b16 a[232:233], v18 offset:16384
    ds_read_b64_tr_b16 a[234:235], v18 offset:17408
    buffer_load_dwordx4 v43, s[40:43], s12 offen offset:3072 lds
    v_mfma_f32_32x32x16_bf16 v[112:127], a[252:255], v[236:239], v[112:127]
    ds_read_b64_tr_b16 a[236:237], v19 offset:16384
    ds_read_b64_tr_b16 a[238:239], v19 offset:17408
    v_mfma_f32_16x16x32_bf16 v[24:27], a[240:243], v[20:23], v[24:27]
    s_waitcnt lgkmcnt(6)
    v_mfma_f32_32x32x16_bf16 v[64:79], a[224:227], v[240:243], v[64:79]
    ds_read_b128 v[244:247], v13 offset:16384
    ds_read_b64_tr_b16 a[240:241], v16 offset:20480
    ds_read_b64_tr_b16 a[242:243], v16 offset:21504
    s_waitcnt lgkmcnt(7)
    v_mfma_f32_32x32x16_bf16 v[80:95], a[228:231], v[240:243], v[80:95]
    ds_read_b64_tr_b16 a[244:245], v17 offset:20480
    ds_read_b64_tr_b16 a[246:247], v17 offset:21504
    s_add_u32 m0, s24, 32768
    s_lshl4_add_u32 s12, s17, s23
    s_waitcnt lgkmcnt(7)
    v_mfma_f32_32x32x16_bf16 v[96:111], a[232:235], v[240:243], v[96:111]
    ds_read_b64_tr_b16 a[248:249], v18 offset:20480
    ds_read_b64_tr_b16 a[250:251], v18 offset:21504
    buffer_load_dwordx4 v40, s[40:43], s12 offen offset:0 lds
    s_waitcnt lgkmcnt(7)
    v_mfma_f32_32x32x16_bf16 v[112:127], a[236:239], v[240:243], v[112:127]
    ds_read_b64_tr_b16 a[252:253], v19 offset:20480
    ds_read_b64_tr_b16 a[254:255], v19 offset:21504
    v_mfma_f32_16x16x32_bf16 v[24:27], a[224:227], v[20:23], v[24:27]
    s_waitcnt lgkmcnt(6)
    v_mfma_f32_32x32x16_bf16 v[64:79], a[240:243], v[244:247], v[64:79]
    ds_read_b128 v[248:251], v14 offset:16384
    ds_read_b64_tr_b16 a[224:225], v16 offset:24576
    ds_read_b64_tr_b16 a[226:227], v16 offset:25600
    s_waitcnt lgkmcnt(7)
    v_mfma_f32_32x32x16_bf16 v[80:95], a[244:247], v[244:247], v[80:95]
    ds_read_b64_tr_b16 a[228:229], v17 offset:24576
    ds_read_b64_tr_b16 a[230:231], v17 offset:25600
    buffer_load_dwordx4 v41, s[40:43], s12 offen offset:1024 lds
    s_waitcnt lgkmcnt(7)
    v_mfma_f32_32x32x16_bf16 v[96:111], a[248:251], v[244:247], v[96:111]
    ds_read_b64_tr_b16 a[232:233], v18 offset:24576
    ds_read_b64_tr_b16 a[234:235], v18 offset:25600
    buffer_load_dwordx4 v42, s[40:43], s12 offen offset:2048 lds
    s_waitcnt lgkmcnt(7)
    v_mfma_f32_32x32x16_bf16 v[112:127], a[252:255], v[244:247], v[112:127]
    ds_read_b64_tr_b16 a[236:237], v19 offset:24576
    ds_read_b64_tr_b16 a[238:239], v19 offset:25600
    v_mfma_f32_16x16x32_bf16 v[24:27], a[240:243], v[20:23], v[24:27]
    s_waitcnt lgkmcnt(6)
    v_mfma_f32_32x32x16_bf16 v[64:79], a[224:227], v[248:251], v[64:79]
    ds_read_b128 v[252:255], v15 offset:16384
    ds_read_b64_tr_b16 a[240:241], v16 offset:28672
    ds_read_b64_tr_b16 a[242:243], v16 offset:29696
    s_waitcnt lgkmcnt(7)
    v_mfma_f32_32x32x16_bf16 v[80:95], a[228:231], v[248:251], v[80:95]
    ds_read_b64_tr_b16 a[244:245], v17 offset:28672
    ds_read_b64_tr_b16 a[246:247], v17 offset:29696
    buffer_load_dwordx4 v43, s[40:43], s12 offen offset:3072 lds
    s_waitcnt lgkmcnt(7)
    v_mfma_f32_32x32x16_bf16 v[96:111], a[232:235], v[248:251], v[96:111]
    ds_read_b64_tr_b16 a[248:249], v18 offset:28672
    ds_read_b64_tr_b16 a[250:251], v18 offset:29696
    s_waitcnt lgkmcnt(7)
    v_mfma_f32_32x32x16_bf16 v[112:127], a[236:239], v[248:251], v[112:127]
    ds_read_b64_tr_b16 a[252:253], v19 offset:28672
    ds_read_b64_tr_b16 a[254:255], v19 offset:29696
    v_mfma_f32_16x16x32_bf16 v[24:27], a[224:227], v[20:23], v[24:27]
    s_waitcnt lgkmcnt(6)
    v_mfma_f32_16x16x32_bf16 v[24:27], a[240:243], v[20:23], v[24:27]
    v_mfma_f32_32x32x16_bf16 v[64:79], a[240:243], v[252:255], v[64:79]
    s_waitcnt vmcnt(12)
    v_cmp_ne_u32 s[98:99], s25, v29
    v_cmp_ne_u32 vcc, s25, v31
    s_nop 2
    s_or_b64 vcc, vcc, s[98:99]
    s_cbranch_scc1 L_st_slow4
L_st_ok4:
    s_waitcnt lgkmcnt(4)
    v_mfma_f32_32x32x16_bf16 v[80:95], a[244:247], v[252:255], v[80:95]
    v_add_f32 v3, 0x3727c5ac, v30
    v_rsq_f32 v3, v3
    s_nop 0
    v_mul_f32 v2, v30, v3
    v_fmaak_f32 v2, v2, v3, 0x3727c5ac
    s_waitcnt lgkmcnt(2)
    v_mfma_f32_32x32x16_bf16 v[96:111], a[248:251], v[252:255], v[96:111]
    v_rsq_f32 v2, v2
    ds_write_b32 v38, v3 offset:256
    v_mul_f32 v36, v2, v3
    v_mul_f32 v37, -v28, v36
    s_mov_b32 exec_lo, 0x00110011
    s_mov_b32 exec_hi, 0x00110011
    ds_write_b128 v60, v[24:27]
    s_mov_b64 exec, -1
    s_waitcnt lgkmcnt(2)
    v_mfma_f32_32x32x16_bf16 v[112:127], a[252:255], v[252:255], v[112:127]
    s_waitcnt lgkmcnt(0)
    ds_read_b128 v[4:7], v48 offset:0
    ds_read_b128 v[12:15], v48 offset:128
    ds_read_b128 v[8:11], v48 offset:32
    ds_read_b128 v[16:19], v48 offset:160
    s_waitcnt lgkmcnt(2)
    v_pk_fma_f32 v[52:53], v[36:37], v[4:5], v[12:13] op_sel:[1,0,0] op_sel_hi:[1,1,1]
    v_pk_fma_f32 v[54:55], v[36:37], v[6:7], v[14:15] op_sel:[1,0,0] op_sel_hi:[1,1,1]
    s_waitcnt lgkmcnt(0)
    v_pk_fma_f32 v[56:57], v[36:37], v[8:9], v[16:17] op_sel:[1,0,0] op_sel_hi:[1,1,1]
    v_pk_fma_f32 v[58:59], v[36:37], v[10:11], v[18:19] op_sel:[1,0,0] op_sel_hi:[1,1,1]
    ds_read_b128 v[20:23], v48 offset:64
    ds_read_b128 v[28:31], v48 offset:192
    ds_read_b128 v[24:27], v48 offset:96
    ds_read_b128 v[32:35], v48 offset:224
    v_pk_fma_f32 v[64:65], v[64:65], v[36:37], v[52:53] op_sel_hi:[1,0,1]
    v_pk_fma_f32 v[66:67], v[66:67], v[36:37], v[54:55] op_sel_hi:[1,0,1]
    v_pk_fma_f32 v[68:69], v[68:69], v[36:37], v[56:57] op_sel_hi:[1,0,1]
    v_pk_fma_f32 v[70:71], v[70:71], v[36:37], v[58:59] op_sel_hi:[1,0,1]
    v_pk_mul_f32 v[52:53], v[64:65], v[64:65]
    v_pk_mul_f32 v[54:55], v[66:67], v[66:67]
    v_pk_mul_f32 v[56:57], v[68:69], v[68:69]
    v_pk_mul_f32 v[58:59], v[70:71], v[70:71]
    v_pk_fma_f32 v[52:53], v[52:53], s[80:81], s[80:81] op_sel:[0,0,1] op_sel_hi:[1,0,1]
    v_pk_fma_f32 v[54:55], v[54:55], s[80:81], s[80:81] op_sel:[0,0,1] op_sel_hi:[1,0,1]
    v_pk_fma_f32 v[56:57], v[56:57], s[80:81], s[80:81] op_sel:[0,0,1] op_sel_hi:[1,0,1]
    v_pk_fma_f32 v[58:59], v[58:59], s[80:81], s[80:81] op_sel:[0,0,1] op_sel_hi:[1,0,1]
    v_pk_mul_f32 v[52:53], v[64:65], v[52:53]
    v_pk_mul_f32 v[54:55], v[66:67], v[54:55]
    s_add_u32 m0, s24, 36864
    s_add_u32 s12, s12, 0x8000
    v_pk_mul_f32 v[56:57], v[68:69], v[56:57]
    buffer_load_dwordx4 v40, s[40:43], s12 offen offset:0 lds
    v_pk_mul_f32 v[58:59], v[70:71], v[58:59]
    v_exp_f32 v52, v52
    v_exp_f32 v53, v53
    v_exp_f32 v54, v54
    v_exp_f32 v55, v55
    v_exp_f32 v56, v56
    v_exp_f32 v57, v57
    v_exp_f32 v58, v58
    v_exp_f32 v59, v59
    v_pk_add_f32 v[52:53], v[52:53], 1.0 op_sel_hi:[1,0]
    v_pk_add_f32 v[54:55], v[54:55], 1.0 op_sel_hi:[1,0]
    v_pk_add_f32 v[56:57], v[56:57], 1.0 op_sel_hi:[1,0]
    v_pk_add_f32 v[58:59], v[58:59], 1.0 op_sel_hi:[1,0]
    v_rcp_f32 v52, v52
    v_rcp_f32 v53, v53
    buffer_load_dwordx4 v41, s[40:43], s12 offen offset:1024 lds
    v_rcp_f32 v54, v54
    v_rcp_f32 v55, v55
    v_rcp_f32 v56, v56
    v_rcp_f32 v57, v57
    v_rcp_f32 v58, v58
    v_rcp_f32 v59, v59
    v_pk_mul_f32 v[52:53], v[64:65], v[52:53]
    v_pk_mul_f32 v[54:55], v[66:67], v[54:55]
    v_pk_mul_f32 v[56:57], v[68:69], v[56:57]
    v_pk_mul_f32 v[58:59], v[70:71], v[58:59]
    v_cvt_pk_bf16_f32 v64, v52, v53
    v_cvt_pk_bf16_f32 v65, v54, v55
    v_cvt_pk_bf16_f32 v66, v56, v57
    v_cvt_pk_bf16_f32 v67, v58, v59
    buffer_store_dwordx4 v[64:67], v46, s[44:47], s68 offen offset:0 sc1
    s_waitcnt lgkmcnt(2)
    v_pk_fma_f32 v[52:53], v[36:37], v[20:21], v[28:29] op_sel:[1,0,0] op_sel_hi:[1,1,1]
    v_pk_fma_f32 v[54:55], v[36:37], v[22:23], v[30:31] op_sel:[1,0,0] op_sel_hi:[1,1,1]
    s_waitcnt lgkmcnt(0)
    v_pk_fma_f32 v[56:57], v[36:37], v[24:25], v[32:33] op_sel:[1,0,0] op_sel_hi:[1,1,1]
    v_pk_fma_f32 v[58:59], v[36:37], v[26:27], v[34:35] op_sel:[1,0,0] op_sel_hi:[1,1,1]
    s_barrier
    ds_read_b128 v[4:7], v49 offset:0
    ds_read_b128 v[12:15], v49 offset:128
    ds_read_b128 v[8:11], v49 offset:32
    ds_read_b128 v[16:19], v49 offset:160
    v_pk_fma_f32 v[72:73], v[72:73], v[36:37], v[52:53] op_sel_hi:[1,0,1]
    v_pk_fma_f32 v[74:75], v[74:75], v[36:37], v[54:55] op_sel_hi:[1,0,1]
    v_pk_fma_f32 v[76:77], v[76:77], v[36:37], v[56:57] op_sel_hi:[1,0,1]
    v_pk_fma_f32 v[78:79], v[78:79], v[36:37], v[58:59] op_sel_hi:[1,0,1]
    v_pk_mul_f32 v[52:53], v[72:73], v[72:73]
    v_pk_mul_f32 v[54:55], v[74:75], v[74:75]
    v_pk_mul_f32 v[56:57], v[76:77], v[76:77]
    v_pk_mul_f32 v[58:59], v[78:79], v[78:79]
    v_pk_fma_f32 v[52:53], v[52:53], s[80:81], s[80:81] op_sel:[0,0,1] op_sel_hi:[1,0,1]
    v_pk_fma_f32 v[54:55], v[54:55], s[80:81], s[80:81] op_sel:[0,0,1] op_sel_hi:[1,0,1]
    v_pk_fma_f32 v[56:57], v[56:57], s[80:81], s[80:81] op_sel:[0,0,1] op_sel_hi:[1,0,1]
    v_pk_fma_f32 v[58:59], v[58:59], s[80:81], s[80:81] op_sel:[0,0,1] op_sel_hi:[1,0,1]
    buffer_load_dwordx4 v42, s[40:43], s12 offen offset:2048 lds
    v_pk_mul_f32 v[52:53], v[72:73], v[52:53]
    v_pk_mul_f32 v[54:55], v[74:75], v[54:55]
    v_pk_mul_f32 v[56:57], v[76:77], v[56:57]
    v_pk_mul_f32 v[58:59], v[78:79], v[58:59]
    v_exp_f32 v52, v52
    v_exp_f32 v53, v53
    v_exp_f32 v54, v54
    v_exp_f32 v55, v55
    v_exp_f32 v56, v56
    v_exp_f32 v57, v57
    v_exp_f32 v58, v58
    buffer_load_dwordx4 v43, s[40:43], s12 offen offset:3072 lds
    v_exp_f32 v59, v59
    v_pk_add_f32 v[52:53], v[52:53], 1.0 op_sel_hi:[1,0]
    v_pk_add_f32 v[54:55], v[54:55], 1.0 op_sel_hi:[1,0]
    v_pk_add_f32 v[56:57], v[56:57], 1.0 op_sel_hi:[1,0]
    v_pk_add_f32 v[58:59], v[58:59], 1.0 op_sel_hi:[1,0]
    v_rcp_f32 v52, v52
    v_rcp_f32 v53, v53
    v_rcp_f32 v54, v54
    v_rcp_f32 v55, v55
    v_rcp_f32 v56, v56
    s_add_u32 m0, s24, 0
    s_lshl4_add_u32 s12, s18, s23
    v_rcp_f32 v57, v57
    buffer_load_dwordx4 v40, s[40:43], s12 offen offset:0 lds
    v_rcp_f32 v58, v58
    v_rcp_f32 v59, v59
    v_pk_mul_f32 v[52:53], v[72:73], v[52:53]
    v_pk_mul_f32 v[54:55], v[74:75], v[54:55]
    v_pk_mul_f32 v[56:57], v[76:77], v[56:57]
    v_pk_mul_f32 v[58:59], v[78:79], v[58:59]
    v_cvt_pk_bf16_f32 v72, v52, v53
    v_cvt_pk_bf16_f32 v73, v54, v55
    v_cvt_pk_bf16_f32 v74, v56, v57
    v_cvt_pk_bf16_f32 v75, v58, v59
    buffer_store_dwordx4 v[72:75], v46, s[44:47], s68 offen offset:1024 sc1
    s_waitcnt lgkmcnt(2)
    v_pk_fma_f32 v[52:53], v[36:37], v[4:5], v[12:13] op_sel:[1,0,0] op_sel_hi:[1,1,1]
    v_pk_fma_f32 v[54:55], v[36:37], v[6:7], v[14:15] op_sel:[1,0,0] op_sel_hi:[1,1,1]
    s_waitcnt lgkmcnt(0)
    v_pk_fma_f32 v[56:57], v[36:37], v[8:9], v[16:17] op_sel:[1,0,0] op_sel_hi:[1,1,1]
    v_pk_fma_f32 v[58:59], v[36:37], v[10:11], v[18:19] op_sel:[1,0,0] op_sel_hi:[1,1,1]
    ds_read_b128 v[20:23], v49 offset:64
    ds_read_b128 v[28:31], v49 offset:192
    ds_read_b128 v[24:27], v49 offset:96
    ds_read_b128 v[32:35], v49 offset:224
    v_pk_fma_f32 v[80:81], v[80:81], v[36:37], v[52:53] op_sel_hi:[1,0,1]
    v_pk_fma_f32 v[82:83], v[82:83], v[36:37], v[54:55] op_sel_hi:[1,0,1]
    v_pk_fma_f32 v[84:85], v[84:85], v[36:37], v[56:57] op_sel_hi:[1,0,1]
    v_pk_fma_f32 v[86:87], v[86:87], v[36:37], v[58:59] op_sel_hi:[1,0,1]
    v_pk_mul_f32 v[52:53], v[80:81], v[80:81]
    v_pk_mul_f32 v[54:55], v[82:83], v[82:83]
    v_pk_mul_f32 v[56:57], v[84:85], v[84:85]
    v_pk_mul_f32 v[58:59], v[86:87], v[86:87]
    v_pk_fma_f32 v[52:53], v[52:53], s[80:81], s[80:81] op_sel:[0,0,1] op_sel_hi:[1,0,1]
    v_pk_fma_f32 v[54:55], v[54:55], s[80:81], s[80:81] op_sel:[0,0,1] op_sel_hi:[1,0,1]
    v_pk_fma_f32 v[56:57], v[56:57], s[80:81], s[80:81] op_sel:[0,0,1] op_sel_hi:[1,0,1]
    v_pk_fma_f32 v[58:59], v[58:59], s[80:81], s[80:81] op_sel:[0,0,1] op_sel_hi:[1,0,1]
    buffer_load_dwordx4 v41, s[40:43], s12 offen offset:1024 lds
    v_pk_mul_f32 v[52:53], v[80:81], v[52:53]
    v_pk_mul_f32 v[54:55], v[82:83], v[54:55]
    v_pk_mul_f32 v[56:57], v[84:85], v[56:57]
    v_pk_mul_f32 v[58:59], v[86:87], v[58:59]
    v_exp_f32 v52, v52
    v_exp_f32 v53, v53
    v_exp_f32 v54, v54
    v_exp_f32 v55, v55
    v_exp_f32 v56, v56
    v_exp_f32 v57, v57
    v_exp_f32 v58, v58
    buffer_load_dwordx4 v42, s[40:43], s12 offen offset:2048 lds
    v_exp_f32 v59, v59
    v_pk_add_f32 v[52:53], v[52:53], 1.0 op_sel_hi:[1,0]
    v_pk_add_f32 v[54:55], v[54:55], 1.0 op_sel_hi:[1,0]
    v_pk_add_f32 v[56:57], v[56:57], 1.0 op_sel_hi:[1,0]
    v_pk_add_f32 v[58:59], v[58:59], 1.0 op_sel_hi:[1,0]
    v_rcp_f32 v52, v52
    v_rcp_f32 v53, v53
    v_rcp_f32 v54, v54
    v_rcp_f32 v55, v55
    v_rcp_f32 v56, v56
    v_rcp_f32 v57, v57
    buffer_load_dwordx4 v43, s[40:43], s12 offen offset:3072 lds
    v_rcp_f32 v58, v58
    v_rcp_f32 v59, v59
    v_pk_mul_f32 v[52:53], v[80:81], v[52:53]
    v_pk_mul_f32 v[54:55], v[82:83], v[54:55]
    v_pk_mul_f32 v[56:57], v[84:85], v[56:57]
    v_pk_mul_f32 v[58:59], v[86:87], v[58:59]
    v_cvt_pk_bf16_f32 v80, v52, v53
    v_cvt_pk_bf16_f32 v81, v54, v55
    v_cvt_pk_bf16_f32 v82, v56, v57
    v_cvt_pk_bf16_f32 v83, v58, v59
    buffer_store_dwordx4 v[80:83], v46, s[44:47], s69 offen offset:0 sc1
    s_waitcnt lgkmcnt(2)
    v_pk_fma_f32 v[52:53], v[36:37], v[20:21], v[28:29] op_sel:[1,0,0] op_sel_hi:[1,1,1]
    v_pk_fma_f32 v[54:55], v[36:37], v[22:23], v[30:31] op_sel:[1,0,0] op_sel_hi:[1,1,1]
    s_waitcnt lgkmcnt(0)
    v_pk_fma_f32 v[56:57], v[36:37], v[24:25], v[32:33] op_sel:[1,0,0] op_sel_hi:[1,1,1]
    v_pk_fma_f32 v[58:59], v[36:37], v[26:27], v[34:35] op_sel:[1,0,0] op_sel_hi:[1,1,1]
    ds_read_b128 v[4:7], v50 offset:0
    ds_read_b128 v[12:15], v50 offset:128
    ds_read_b128 v[8:11], v50 offset:32
    ds_read_b128 v[16:19], v50 offset:160
    v_pk_fma_f32 v[88:89], v[88:89], v[36:37], v[52:53] op_sel_hi:[1,0,1]
    v_pk_fma_f32 v[90:91], v[90:91], v[36:37], v[54:55] op_sel_hi:[1,0,1]
    v_pk_fma_f32 v[92:93], v[92:93], v[36:37], v[56:57] op_sel_hi:[1,0,1]
    v_pk_fma_f32 v[94:95], v[94:95], v[36:37], v[58:59] op_sel_hi:[1,0,1]
    v_pk_mul_f32 v[52:53], v[88:89], v[88:89]
    v_pk_mul_f32 v[54:55], v[90:91], v[90:91]
    v_pk_mul_f32 v[56:57], v[92:93], v[92:93]
    v_pk_mul_f32 v[58:59], v[94:95], v[94:95]
    v_pk_fma_f32 v[52:53], v[52:53], s[80:81], s[80:81] op_sel:[0,0,1] op_sel_hi:[1,0,1]
    v_pk_fma_f32 v[54:55], v[54:55], s[80:81], s[80:81] op_sel:[0,0,1] op_sel_hi:[1,0,1]
    v_pk_fma_f32 v[56:57], v[56:57], s[80:81], s[80:81] op_sel:[0,0,1] op_sel_hi:[1,0,1]
    s_add_u32 m0, s24, 4096
    s_add_u32 s12, s12, 0x8000
    v_pk_fma_f32 v[58:59], v[58:59], s[80:81], s[80:81] op_sel:[0,0,1] op_sel_hi:[1,0,1]
    buffer_load_dwordx4 v40, s[40:43], s12 offen offset:0 lds
    v_pk_mul_f32 v[52:53], v[88:89], v[52:53]
    v_pk_mul_f32 v[54:55], v[90:91], v[54:55]
    v_pk_mul_f32 v[56:57], v[92:93], v[56:57]
    v_pk_mul_f32 v[58:59], v[94:95], v[58:59]
    v_exp_f32 v52, v52
    v_exp_f32 v53, v53
    v_exp_f32 v54, v54
    v_exp_f32 v55, v55
    v_exp_f32 v56, v56
    v_exp_f32 v57, v57
    v_exp_f32 v58, v58
    buffer_load_dwordx4 v41, s[40:43], s12 offen offset:1024 lds
    v_exp_f32 v59, v59
    v_pk_add_f32 v[52:53], v[52:53], 1.0 op_sel_hi:[1,0]
    v_pk_add_f32 v[54:55], v[54:55], 1.0 op_sel_hi:[1,0]
    v_pk_add_f32 v[56:57], v[56:57], 1.0 op_sel_hi:[1,0]
    v_pk_add_f32 v[58:59], v[58:59], 1.0 op_sel_hi:[1,0]
    v_rcp_f32 v52, v52
    v_rcp_f32 v53, v53
    v_rcp_f32 v54, v54
    v_rcp_f32 v55, v55
    v_rcp_f32 v56, v56
    v_rcp_f32 v57, v57
    buffer_load_dwordx4 v42, s[40:43], s12 offen offset:2048 lds
    v_rcp_f32 v58, v58
    v_rcp_f32 v59, v59
    v_pk_mul_f32 v[52:53], v[88:89], v[52:53]
    v_pk_mul_f32 v[54:55], v[90:91], v[54:55]
    v_pk_mul_f32 v[56:57], v[92:93], v[56:57]
    v_pk_mul_f32 v[58:59], v[94:95], v[58:59]
    v_cvt_pk_bf16_f32 v88, v52, v53
    v_cvt_pk_bf16_f32 v89, v54, v55
    v_cvt_pk_bf16_f32 v90, v56, v57
    v_cvt_pk_bf16_f32 v91, v58, v59
    buffer_store_dwordx4 v[88:91], v46, s[44:47], s69 offen offset:1024 sc1
    s_waitcnt lgkmcnt(2)
    v_pk_fma_f32 v[52:53], v[36:37], v[4:5], v[12:13] op_sel:[1,0,0] op_sel_hi:[1,1,1]
    v_pk_fma_f32 v[54:55], v[36:37], v[6:7], v[14:15] op_sel:[1,0,0] op_sel_hi:[1,1,1]
    s_waitcnt lgkmcnt(0)
    v_pk_fma_f32 v[56:57], v[36:37], v[8:9], v[16:17] op_sel:[1,0,0] op_sel_hi:[1,1,1]
    v_pk_fma_f32 v[58:59], v[36:37], v[10:11], v[18:19] op_sel:[1,0,0] op_sel_hi:[1,1,1]
    ds_read_b128 v[20:23], v50 offset:64
    ds_read_b128 v[28:31], v50 offset:192
    ds_read_b128 v[24:27], v50 offset:96
    ds_read_b128 v[32:35], v50 offset:224
    v_pk_fma_f32 v[96:97], v[96:97], v[36:37], v[52:53] op_sel_hi:[1,0,1]
    v_pk_fma_f32 v[98:99], v[98:99], v[36:37], v[54:55] op_sel_hi:[1,0,1]
    v_pk_fma_f32 v[100:101], v[100:101], v[36:37], v[56:57] op_sel_hi:[1,0,1]
    v_pk_fma_f32 v[102:103], v[102:103], v[36:37], v[58:59] op_sel_hi:[1,0,1]
    v_pk_mul_f32 v[52:53], v[96:97], v[96:97]
    v_pk_mul_f32 v[54:55], v[98:99], v[98:99]
    v_pk_mul_f32 v[56:57], v[100:101], v[100:101]
    v_pk_mul_f32 v[58:59], v[102:103], v[102:103]
    v_pk_fma_f32 v[52:53], v[52:53], s[80:81], s[80:81] op_sel:[0,0,1] op_sel_hi:[1,0,1]
    v_pk_fma_f32 v[54:55], v[54:55], s[80:81], s[80:81] op_sel:[0,0,1] op_sel_hi:[1,0,1]
    v_pk_fma_f32 v[56:57], v[56:57], s[80:81], s[80:81] op_sel:[0,0,1] op_sel_hi:[1,0,1]
    v_pk_fma_f32 v[58:59], v[58:59], s[80:81], s[80:81] op_sel:[0,0,1] op_sel_hi:[1,0,1]
    buffer_load_dwordx4 v43, s[40:43], s12 offen offset:3072 lds
    v_pk_mul_f32 v[52:53], v[96:97], v[52:53]
    v_pk_mul_f32 v[54:55], v[98:99], v[54:55]
    v_pk_mul_f32 v[56:57], v[100:101], v[56:57]
    v_pk_mul_f32 v[58:59], v[102:103], v[58:59]
    v_exp_f32 v52, v52
    v_exp_f32 v53, v53
    v_exp_f32 v54, v54
    v_exp_f32 v55, v55
    v_exp_f32 v56, v56
    v_exp_f32 v57, v57
    s_add_u32 m0, s24, 16384
    s_lshl4_add_u32 s12, s19, s23
    v_exp_f32 v58, v58
    buffer_load_dwordx4 v40, s[40:43], s12 offen offset:0 lds
    v_exp_f32 v59, v59
    v_pk_add_f32 v[52:53], v[52:53], 1.0 op_sel_hi:[1,0]
    v_pk_add_f32 v[54:55], v[54:55], 1.0 op_sel_hi:[1,0]
    v_pk_add_f32 v[56:57], v[56:57], 1.0 op_sel_hi:[1,0]
    v_pk_add_f32 v[58:59], v[58:59], 1.0 op_sel_hi:[1,0]
    v_rcp_f32 v52, v52
    v_rcp_f32 v53, v53
    v_rcp_f32 v54, v54
    v_rcp_f32 v55, v55
    v_rcp_f32 v56, v56
    v_rcp_f32 v57, v57
    buffer_load_dwordx4 v41, s[40:43], s12 offen offset:1024 lds
    v_rcp_f32 v58, v58
    v_rcp_f32 v59, v59
    v_pk_mul_f32 v[52:53], v[96:97], v[52:53]
    v_pk_mul_f32 v[54:55], v[98:99], v[54:55]
    v_pk_mul_f32 v[56:57], v[100:101], v[56:57]
    v_pk_mul_f32 v[58:59], v[102:103], v[58:59]
    v_cvt_pk_bf16_f32 v96, v52, v53
    v_cvt_pk_bf16_f32 v97, v54, v55
    v_cvt_pk_bf16_f32 v98, v56, v57
    v_cvt_pk_bf16_f32 v99, v58, v59
    buffer_store_dwordx4 v[96:99], v46, s[44:47], s70 offen offset:0 sc1
    s_waitcnt lgkmcnt(2)
    v_pk_fma_f32 v[52:53], v[36:37], v[20:21], v[28:29] op_sel:[1,0,0] op_sel_hi:[1,1,1]
    v_pk_fma_f32 v[54:55], v[36:37], v[22:23], v[30:31] op_sel:[1,0,0] op_sel_hi:[1,1,1]
    s_waitcnt lgkmcnt(0)
    v_pk_fma_f32 v[56:57], v[36:37], v[24:25], v[32:33] op_sel:[1,0,0] op_sel_hi:[1,1,1]
    v_pk_fma_f32 v[58:59], v[36:37], v[26:27], v[34:35] op_sel:[1,0,0] op_sel_hi:[1,1,1]
    ds_read_b128 v[4:7], v51 offset:0
    ds_read_b128 v[12:15], v51 offset:128
    ds_read_b128 v[8:11], v51 offset:32
    ds_read_b128 v[16:19], v51 offset:160
    v_pk_fma_f32 v[104:105], v[104:105], v[36:37], v[52:53] op_sel_hi:[1,0,1]
    v_pk_fma_f32 v[106:107], v[106:107], v[36:37], v[54:55] op_sel_hi:[1,0,1]
    v_pk_fma_f32 v[108:109], v[108:109], v[36:37], v[56:57] op_sel_hi:[1,0,1]
    v_pk_fma_f32 v[110:111], v[110:111], v[36:37], v[58:59] op_sel_hi:[1,0,1]
    v_pk_mul_f32 v[52:53], v[104:105], v[104:105]
    v_pk_mul_f32 v[54:55], v[106:107], v[106:107]
    v_pk_mul_f32 v[56:57], v[108:109], v[108:109]
    v_pk_mul_f32 v[58:59], v[110:111], v[110:111]
    v_pk_fma_f32 v[52:53], v[52:53], s[80:81], s[80:81] op_sel:[0,0,1] op_sel_hi:[1,0,1]
    v_pk_fma_f32 v[54:55], v[54:55], s[80:81], s[80:81] op_sel:[0,0,1] op_sel_hi:[1,0,1]
    v_pk_fma_f32 v[56:57], v[56:57], s[80:81], s[80:81] op_sel:[0,0,1] op_sel_hi:[1,0,1]
    v_pk_fma_f32 v[58:59], v[58:59], s[80:81], s[80:81] op_sel:[0,0,1] op_sel_hi:[1,0,1]
    buffer_load_dwordx4 v42, s[40:43], s12 offen offset:2048 lds
    v_pk_mul_f32 v[52:53], v[104:105], v[52:53]
    v_pk_mul_f32 v[54:55], v[106:107], v[54:55]
    v_pk_mul_f32 v[56:57], v[108:109], v[56:57]
    v_pk_mul_f32 v[58:59], v[110:111], v[58:59]
    v_exp_f32 v52, v52
    v_exp_f32 v53, v53
    v_exp_f32 v54, v54
    v_exp_f32 v55, v55
    v_exp_f32 v56, v56
    v_exp_f32 v57, v57
    v_exp_f32 v58, v58
    buffer_load_dwordx4 v43, s[40:43], s12 offen offset:3072 lds
    v_exp_f32 v59, v59
    v_pk_add_f32 v[52:53], v[52:53], 1.0 op_sel_hi:[1,0]
    v_pk_add_f32 v[54:55], v[54:55], 1.0 op_sel_hi:[1,0]
    v_pk_add_f32 v[56:57], v[56:57], 1.0 op_sel_hi:[1,0]
    v_pk_add_f32 v[58:59], v[58:59], 1.0 op_sel_hi:[1,0]
    v_rcp_f32 v52, v52
    v_rcp_f32 v53, v53
    v_rcp_f32 v54, v54
    v_rcp_f32 v55, v55
    v_rcp_f32 v56, v56
    s_add_u32 m0, s24, 20480
    s_add_u32 s12, s12, 0x8000
    v_rcp_f32 v57, v57
    buffer_load_dwordx4 v40, s[40:43], s12 offen offset:0 lds
    v_rcp_f32 v58, v58
    v_rcp_f32 v59, v59
    v_pk_mul_f32 v[52:53], v[104:105], v[52:53]
    v_pk_mul_f32 v[54:55], v[106:107], v[54:55]
    v_pk_mul_f32 v[56:57], v[108:109], v[56:57]
    v_pk_mul_f32 v[58:59], v[110:111], v[58:59]
    v_cvt_pk_bf16_f32 v104, v52, v53
    v_cvt_pk_bf16_f32 v105, v54, v55
    v_cvt_pk_bf16_f32 v106, v56, v57
    v_cvt_pk_bf16_f32 v107, v58, v59
    buffer_store_dwordx4 v[104:107], v46, s[44:47], s70 offen offset:1024 sc1
    s_waitcnt lgkmcnt(2)
    v_pk_fma_f32 v[52:53], v[36:37], v[4:5], v[12:13] op_sel:[1,0,0] op_sel_hi:[1,1,1]
    v_pk_fma_f32 v[54:55], v[36:37], v[6:7], v[14:15] op_sel:[1,0,0] op_sel_hi:[1,1,1]
    s_waitcnt lgkmcnt(0)
    v_pk_fma_f32 v[56:57], v[36:37], v[8:9], v[16:17] op_sel:[1,0,0] op_sel_hi:[1,1,1]
    v_pk_fma_f32 v[58:59], v[36:37], v[10:11], v[18:19] op_sel:[1,0,0] op_sel_hi:[1,1,1]
    ds_read_b128 v[20:23], v51 offset:64
    ds_read_b128 v[28:31], v51 offset:192
    ds_read_b128 v[24:27], v51 offset:96
    ds_read_b128 v[32:35], v51 offset:224
    v_pk_fma_f32 v[112:113], v[112:113], v[36:37], v[52:53] op_sel_hi:[1,0,1]
    v_pk_fma_f32 v[114:115], v[114:115], v[36:37], v[54:55] op_sel_hi:[1,0,1]
    v_pk_fma_f32 v[116:117], v[116:117], v[36:37], v[56:57] op_sel_hi:[1,0,1]
    v_pk_fma_f32 v[118:119], v[118:119], v[36:37], v[58:59] op_sel_hi:[1,0,1]
    v_pk_mul_f32 v[52:53], v[112:113], v[112:113]
    v_pk_mul_f32 v[54:55], v[114:115], v[114:115]
    v_pk_mul_f32 v[56:57], v[116:117], v[116:117]
    v_pk_mul_f32 v[58:59], v[118:119], v[118:119]
    v_pk_fma_f32 v[52:53], v[52:53], s[80:81], s[80:81] op_sel:[0,0,1] op_sel_hi:[1,0,1]
    v_pk_fma_f32 v[54:55], v[54:55], s[80:81], s[80:81] op_sel:[0,0,1] op_sel_hi:[1,0,1]
    v_pk_fma_f32 v[56:57], v[56:57], s[80:81], s[80:81] op_sel:[0,0,1] op_sel_hi:[1,0,1]
    v_pk_fma_f32 v[58:59], v[58:59], s[80:81], s[80:81] op_sel:[0,0,1] op_sel_hi:[1,0,1]
    buffer_load_dwordx4 v41, s[40:43], s12 offen offset:1024 lds
    v_pk_mul_f32 v[52:53], v[112:113], v[52:53]
    v_pk_mul_f32 v[54:55], v[114:115], v[54:55]
    v_pk_mul_f32 v[56:57], v[116:117], v[56:57]
    v_pk_mul_f32 v[58:59], v[118:119], v[58:59]
    v_exp_f32 v52, v52
    v_exp_f32 v53, v53
    v_exp_f32 v54, v54
    v_exp_f32 v55, v55
    v_exp_f32 v56, v56
    v_exp_f32 v57, v57
    v_exp_f32 v58, v58
    buffer_load_dwordx4 v42, s[40:43], s12 offen offset:2048 lds
    v_exp_f32 v59, v59
    v_pk_add_f32 v[52:53], v[52:53], 1.0 op_sel_hi:[1,0]
    v_pk_add_f32 v[54:55], v[54:55], 1.0 op_sel_hi:[1,0]
    v_pk_add_f32 v[56:57], v[56:57], 1.0 op_sel_hi:[1,0]
    v_pk_add_f32 v[58:59], v[58:59], 1.0 op_sel_hi:[1,0]
    v_rcp_f32 v52, v52
    v_rcp_f32 v53, v53
    v_rcp_f32 v54, v54
    v_rcp_f32 v55, v55
    v_rcp_f32 v56, v56
    v_rcp_f32 v57, v57
    buffer_load_dwordx4 v43, s[40:43], s12 offen offset:3072 lds
    v_rcp_f32 v58, v58
    v_rcp_f32 v59, v59
    v_pk_mul_f32 v[52:53], v[112:113], v[52:53]
    v_pk_mul_f32 v[54:55], v[114:115], v[54:55]
    v_pk_mul_f32 v[56:57], v[116:117], v[56:57]
    v_pk_mul_f32 v[58:59], v[118:119], v[58:59]
    v_cvt_pk_bf16_f32 v112, v52, v53
    v_cvt_pk_bf16_f32 v113, v54, v55
    v_cvt_pk_bf16_f32 v114, v56, v57
    v_cvt_pk_bf16_f32 v115, v58, v59
    buffer_store_dwordx4 v[112:115], v46, s[44:47], s71 offen offset:0 sc1
    s_waitcnt lgkmcnt(2)
    v_pk_fma_f32 v[52:53], v[36:37], v[20:21], v[28:29] op_sel:[1,0,0] op_sel_hi:[1,1,1]
    v_pk_fma_f32 v[54:55], v[36:37], v[22:23], v[30:31] op_sel:[1,0,0] op_sel_hi:[1,1,1]
    s_waitcnt lgkmcnt(0)
    v_pk_fma_f32 v[56:57], v[36:37], v[24:25], v[32:33] op_sel:[1,0,0] op_sel_hi:[1,1,1]
    v_pk_fma_f32 v[58:59], v[36:37], v[26:27], v[34:35] op_sel:[1,0,0] op_sel_hi:[1,1,1]
    v_pk_fma_f32 v[120:121], v[120:121], v[36:37], v[52:53] op_sel_hi:[1,0,1]
    v_pk_fma_f32 v[122:123], v[122:123], v[36:37], v[54:55] op_sel_hi:[1,0,1]
    v_pk_fma_f32 v[124:125], v[124:125], v[36:37], v[56:57] op_sel_hi:[1,0,1]
    v_pk_fma_f32 v[126:127], v[126:127], v[36:37], v[58:59] op_sel_hi:[1,0,1]
    v_pk_mul_f32 v[52:53], v[120:121], v[120:121]
    v_pk_mul_f32 v[54:55], v[122:123], v[122:123]
    v_pk_mul_f32 v[56:57], v[124:125], v[124:125]
    v_pk_mul_f32 v[58:59], v[126:127], v[126:127]
    v_pk_fma_f32 v[52:53], v[52:53], s[80:81], s[80:81] op_sel:[0,0,1] op_sel_hi:[1,0,1]
    v_pk_fma_f32 v[54:55], v[54:55], s[80:81], s[80:81] op_sel:[0,0,1] op_sel_hi:[1,0,1]
    v_pk_fma_f32 v[56:57], v[56:57], s[80:81], s[80:81] op_sel:[0,0,1] op_sel_hi:[1,0,1]
    v_pk_fma_f32 v[58:59], v[58:59], s[80:81], s[80:81] op_sel:[0,0,1] op_sel_hi:[1,0,1]
    v_pk_mul_f32 v[52:53], v[120:121], v[52:53]
    v_pk_mul_f32 v[54:55], v[122:123], v[54:55]
    v_pk_mul_f32 v[56:57], v[124:125], v[56:57]
    v_pk_mul_f32 v[58:59], v[126:127], v[58:59]
    v_exp_f32 v52, v52
    v_exp_f32 v53, v53
    v_exp_f32 v54, v54
    v_exp_f32 v55, v55
    v_exp_f32 v56, v56
    v_exp_f32 v57, v57
    v_exp_f32 v58, v58
    v_exp_f32 v59, v59
    v_pk_add_f32 v[52:53], v[52:53], 1.0 op_sel_hi:[1,0]
    v_pk_add_f32 v[54:55], v[54:55], 1.0 op_sel_hi:[1,0]
    v_pk_add_f32 v[56:57], v[56:57], 1.0 op_sel_hi:[1,0]
    v_pk_add_f32 v[58:59], v[58:59], 1.0 op_sel_hi:[1,0]
    v_rcp_f32 v52, v52
    v_rcp_f32 v53, v53
    v_rcp_f32 v54, v54
    v_rcp_f32 v55, v55
    v_rcp_f32 v56, v56
    v_rcp_f32 v57, v57
    v_rcp_f32 v58, v58
    v_rcp_f32 v59, v59
    v_pk_mul_f32 v[52:53], v[120:121], v[52:53]
    v_pk_mul_f32 v[54:55], v[122:123], v[54:55]
    v_pk_mul_f32 v[56:57], v[124:125], v[56:57]
    v_pk_mul_f32 v[58:59], v[126:127], v[58:59]
    v_cvt_pk_bf16_f32 v120, v52, v53
    v_cvt_pk_bf16_f32 v121, v54, v55
    v_cvt_pk_bf16_f32 v122, v56, v57
    v_cvt_pk_bf16_f32 v123, v58, v59
    buffer_store_dwordx4 v[120:123], v46, s[44:47], s71 offen offset:1024 sc1
L_gelu_done:
    v_add_u32 v20, 147456, v61
    v_lshrrev_b32 v3, 5, v0
    ds_read_b128 a[224:227], v20 offset:0
    ds_read_b128 a[228:231], v20 offset:1024
    ds_read_b128 a[232:235], v20 offset:2048
    v_lshl_add_u32 v48, v0, 2, s48
    v_mov_b32 v49, s25
    s_sub_u32 s98, s15, s24
    v_subrev_u32 v56, s98, v44
    v_subrev_u32 v57, s98, v45
    s_waitcnt lgkmcnt(2)
    v_mfma_f32_32x32x16_bf16 v[64:79], v[128:131], a[224:227], 0
    ds_read_b128 a[236:239], v20 offset:3072
    s_waitcnt vmcnt(30)
    ds_read_b64_tr_b16 a[0:1], v44 offset:0
    ds_read_b64_tr_b16 a[2:3], v44 offset:1024
    v_mfma_f32_32x32x16_bf16 v[80:95], v[192:195], a[224:227], 0
    ds_read_b64_tr_b16 a[4:5], v45 offset:0
    ds_read_b64_tr_b16 a[6:7], v45 offset:1024
    ds_read_b64_tr_b16 a[8:9], v44 offset:2048
    ds_read_b64_tr_b16 a[10:11], v44 offset:3072
    s_waitcnt lgkmcnt(8)
    v_mfma_f32_32x32x16_bf16 v[64:79], v[132:135], a[228:231], v[64:79]
    ds_read_b128 a[224:227], v20 offset:4096
    ds_read_b64_tr_b16 a[12:13], v45 offset:2048
    ds_read_b64_tr_b16 a[14:15], v45 offset:3072
    ds_read_b64_tr_b16 a[16:17], v44 offset:4096
    v_mfma_f32_32x32x16_bf16 v[80:95], v[196:199], a[228:231], v[80:95]
    ds_read_b64_tr_b16 a[18:19], v44 offset:5120
    ds_read_b64_tr_b16 a[20:21], v45 offset:4096
    ds_read_b64_tr_b16 a[22:23], v45 offset:5120
    ds_read_b64_tr_b16 a[24:25], v44 offset:6144
    s_waitcnt lgkmcnt(15)
    v_mfma_f32_32x32x16_bf16 v[64:79], v[136:139], a[232:235], v[64:79]
    ds_read_b128 a[228:231], v20 offset:5120
    ds_read_b64_tr_b16 a[26:27], v44 offset:7168
    ds_read_b64_tr_b16 a[28:29], v45 offset:6144
    ds_read_b64_tr_b16 a[30:31], v45 offset:7168
    v_mfma_f32_32x32x16_bf16 v[80:95], v[200:203], a[232:235], v[80:95]
    s_waitcnt vmcnt(22)
    ds_read_b64_tr_b16 a[32:33], v56 offset:32768
    ds_read_b64_tr_b16 a[34:35], v56 offset:33792
    ds_read_b64_tr_b16 a[36:37], v57 offset:32768
    s_waitcnt lgkmcnt(15)
    v_mfma_f32_32x32x16_bf16 v[64:79], v[140:143], a[236:239], v[64:79]
    ds_read_b128 a[232:235], v20 offset:6144
    ds_read_b64_tr_b16 a[38:39], v57 offset:33792
    ds_read_b64_tr_b16 a[40:41], v56 offset:34816
    ds_read_b64_tr_b16 a[42:43], v56 offset:35840
    v_mfma_f32_32x32x16_bf16 v[80:95], v[204:207], a[236:239], v[80:95]
    ds_read_b64_tr_b16 a[44:45], v57 offset:34816
    ds_read_b64_tr_b16 a[46:47], v57 offset:35840
    ds_read_b64_tr_b16 a[48:49], v56 offset:36864
    ds_read_b64_tr_b16 a[50:51], v56 offset:37888
    s_waitcnt lgkmcnt(15)
    v_mfma_f32_32x32x16_bf16 v[64:79], v[144:147], a[224:227], v[64:79]
    ds_read_b128 a[236:239], v20 offset:7168
    ds_read_b64_tr_b16 a[52:53], v57 offset:36864
    ds_read_b64_tr_b16 a[54:55], v57 offset:37888
    ds_read_b64_tr_b16 a[56:57], v56 offset:38912
    v_mfma_f32_32x32x16_bf16 v[80:95], v[208:211], a[224:227], v[80:95]
    ds_read_b64_tr_b16 a[58:59], v56 offset:39936
    ds_read_b64_tr_b16 a[60:61], v57 offset:38912
    ds_read_b64_tr_b16 a[62:63], v57 offset:39936
    s_waitcnt lgkmcnt(0)
    v_mfma_f32_32x32x16_bf16 v[64:79], v[148:151], a[228:231], v[64:79]
    ds_read_b128 a[224:227], v20 offset:8192
    s_add_u32 m0, s15, 0
    s_lshl4_add_u32 s12, s20, s23
    buffer_load_dwordx4 v40, s[40:43], s12 offen offset:0 lds
    v_add_u32 v1, 133120, v61
    v_mfma_f32_32x32x16_bf16 v[80:95], v[212:215], a[228:231], v[80:95]
    buffer_load_dwordx4 v41, s[40:43], s12 offen offset:1024 lds
    ds_read_b128 a[160:163], v1 offset:0
    v_mfma_f32_32x32x16_bf16 v[64:79], v[152:155], a[232:235], v[64:79]
    ds_read_b128 a[228:231], v20 offset:9216
    buffer_load_dwordx4 v42, s[40:43], s12 offen offset:2048 lds
    ds_read_b128 a[164:167], v1 offset:1024
    v_mfma_f32_32x32x16_bf16 v[80:95], v[216:219], a[232:235], v[80:95]
    ds_read_b128 a[168:171], v1 offset:2048
    v_mfma_f32_32x32x16_bf16 v[64:79], v[156:159], a[236:239], v[64:79]
    ds_read_b128 a[232:235], v20 offset:10240
    buffer_load_dwordx4 v43, s[40:43], s12 offen offset:3072 lds
    ds_read_b128 a[172:175], v1 offset:3072
    v_mfma_f32_32x32x16_bf16 v[80:95], v[220:223], a[236:239], v[80:95]
    s_add_u32 m0, s15, 4096
    s_add_u32 s12, s12, 0x8000
    buffer_load_dwordx4 v40, s[40:43], s12 offen offset:0 lds
    v_lshrrev_b32 v60, 5, v0
    s_waitcnt lgkmcnt(6)
    v_mfma_f32_32x32x16_bf16 v[64:79], v[160:163], a[224:227], v[64:79]
    ds_read_b128 a[236:239], v20 offset:11264
    buffer_load_dwordx4 v41, s[40:43], s12 offen offset:1024 lds
    v_lshl_add_u32 v1, v60, 4, s82
    v_mfma_f32_32x32x16_bf16 v[80:95], v[224:227], a[224:227], v[80:95]
    ds_read_b128 v[4:7], v1 offset:0
    ds_read_b128 v[8:11], v1 offset:32
    s_waitcnt vmcnt(6)
    s_mov_b64 exec, 0xffff
    buffer_store_dword v49, v48, s[44:47], 0 offen sc1
    s_mov_b64 exec, -1
    s_waitcnt lgkmcnt(7)
    v_mfma_f32_32x32x16_bf16 v[64:79], v[164:167], a[228:231], v[64:79]
    ds_read_b128 a[224:227], v20 offset:12288
    buffer_load_dwordx4 v42, s[40:43], s12 offen offset:2048 lds
    ds_read_b128 v[12:15], v1 offset:64
    v_mfma_f32_32x32x16_bf16 v[80:95], v[228:231], a[228:231], v[80:95]
    buffer_load_dwordx4 v43, s[40:43], s12 offen offset:3072 lds
    ds_read_b128 v[16:19], v1 offset:96
    s_waitcnt lgkmcnt(7)
    v_mfma_f32_32x32x16_bf16 v[64:79], v[168:171], a[232:235], v[64:79]
    ds_read_b128 a[228:231], v20 offset:13312
    v_lshrrev_b32 v1, 4, v0
    v_mfma_f32_32x32x16_bf16 v[80:95], v[232:235], a[232:235], v[80:95]
    s_add_u32 m0, s24, 32768
    s_lshl4_add_u32 s12, s21, s23
    buffer_load_dwordx4 v40, s[40:43], s12 offen offset:0 lds
    v_and_b32 v38, 15, v0
    s_waitcnt lgkmcnt(6)
    v_mfma_f32_32x32x16_bf16 v[64:79], v[172:175], a[236:239], v[64:79]
    ds_read_b128 a[232:235], v20 offset:14336
    buffer_load_dwordx4 v41, s[40:43], s12 offen offset:1024 lds
    v_lshlrev_b32 v38, 4, v38
    v_mfma_f32_32x32x16_bf16 v[80:95], v[236:239], a[236:239], v[80:95]
    buffer_load_dwordx4 v42, s[40:43], s12 offen offset:2048 lds
    v_lshl_add_u32 v46, v1, 16, v38
    s_waitcnt lgkmcnt(4)
    v_mfma_f32_32x32x16_bf16 v[64:79], v[176:179], a[224:227], v[64:79]
    ds_read_b128 a[236:239], v20 offset:15360
    v_lshl_add_u32 v1, v1, 10, v38
    v_add_u32 v47, s83, v1
    v_mfma_f32_32x32x16_bf16 v[80:95], v[240:243], a[224:227], v[80:95]
    buffer_load_dwordx4 v43, s[40:43], s12 offen offset:3072 lds
    v_bfe_u32 v1, v0, 2, 1
    s_waitcnt lgkmcnt(2)
    v_mfma_f32_32x32x16_bf16 v[64:79], v[180:183], a[228:231], v[64:79]
    s_add_u32 m0, s24, 36864
    s_add_u32 s12, s12, 0x8000
    buffer_load_dwordx4 v40, s[40:43], s12 offen offset:0 lds
    v_and_b32 v2, 3, v0
    v_mfma_f32_32x32x16_bf16 v[80:95], v[244:247], a[228:231], v[80:95]
    buffer_load_dwordx4 v41, s[40:43], s12 offen offset:1024 lds
    v_lshl_add_u32 v1, v1, 9, v2
    s_waitcnt lgkmcnt(1)
    v_mfma_f32_32x32x16_bf16 v[64:79], v[184:187], a[232:235], v[64:79]
    v_lshl_add_u32 v50, v1, 6, s49
    v_mfma_f32_32x32x16_bf16 v[80:95], v[248:251], a[232:235], v[80:95]
    buffer_load_dwordx4 v42, s[40:43], s12 offen offset:2048 lds
    v_add_u32 v36, s50, v61
    s_waitcnt lgkmcnt(0)
    v_mfma_f32_32x32x16_bf16 v[64:79], v[188:191], a[236:239], v[64:79]
    buffer_load_dwordx4 v43, s[40:43], s12 offen offset:3072 lds
    v_add_u32 v37, s51, v61
    v_mfma_f32_32x32x16_bf16 v[80:95], v[252:255], a[236:239], v[80:95]
    v_lshlrev_b32 v1, 31, v0
    v_or_b32 v2, 0x3f800000, v1
    s_nop 9
    v_pk_fma_f32 v[64:65], v[80:81], v[2:3], v[64:65] op_sel_hi:[1,0,1]
    v_pk_fma_f32 v[66:67], v[82:83], v[2:3], v[66:67] op_sel_hi:[1,0,1]
    v_pk_fma_f32 v[68:69], v[84:85], v[2:3], v[68:69] op_sel_hi:[1,0,1]
    v_pk_fma_f32 v[70:71], v[86:87], v[2:3], v[70:71] op_sel_hi:[1,0,1]
    v_pk_fma_f32 v[72:73], v[88:89], v[2:3], v[72:73] op_sel_hi:[1,0,1]
    v_pk_fma_f32 v[74:75], v[90:91], v[2:3], v[74:75] op_sel_hi:[1,0,1]
    v_pk_fma_f32 v[76:77], v[92:93], v[2:3], v[76:77] op_sel_hi:[1,0,1]
    v_pk_fma_f32 v[78:79], v[94:95], v[2:3], v[78:79] op_sel_hi:[1,0,1]
    v_pk_mul_f32 v[64:65], v[64:65], v[4:5]
    v_pk_mul_f32 v[66:67], v[66:67], v[6:7]
    v_pk_mul_f32 v[68:69], v[68:69], v[8:9]
    v_pk_mul_f32 v[70:71], v[70:71], v[10:11]
    v_pk_mul_f32 v[72:73], v[72:73], v[12:13]
    v_pk_mul_f32 v[74:75], v[74:75], v[14:15]
    v_pk_mul_f32 v[76:77], v[76:77], v[16:17]
    v_pk_mul_f32 v[78:79], v[78:79], v[18:19]
    v_cvt_pk_bf16_f32 v20, v64, v65
    v_cvt_pk_bf16_f32 v21, v66, v67
    v_cvt_pk_bf16_f32 v22, v68, v69
    v_cvt_pk_bf16_f32 v23, v70, v71
    v_cvt_pk_bf16_f32 v24, v72, v73
    v_cvt_pk_bf16_f32 v25, v74, v75
    v_cvt_pk_bf16_f32 v26, v76, v77
    v_cvt_pk_bf16_f32 v27, v78, v79
    v_xor_b32 v112, 0x80000000, v20
    v_xor_b32 v113, 0x80000000, v21
    v_xor_b32 v114, 0x80000000, v22
    v_xor_b32 v115, 0x80000000, v23
    v_xor_b32 v116, 0x80000000, v24
    v_xor_b32 v117, 0x80000000, v25
    v_xor_b32 v118, 0x80000000, v26
    v_xor_b32 v119, 0x80000000, v27
    v_mfma_f32_16x16x32_bf16 v[80:83], a[160:163], v[20:23], 0
    ds_read_b64_tr_b16 a[64:65], v56 offset:0
    ds_read_b64_tr_b16 a[66:67], v56 offset:1024
    v_mfma_f32_16x16x32_bf16 v[84:87], a[164:167], v[20:23], 0
    ds_read_b64_tr_b16 a[68:69], v57 offset:0
    ds_read_b64_tr_b16 a[70:71], v57 offset:1024
    v_mfma_f32_16x16x32_bf16 v[80:83], a[168:171], v[24:27], v[80:83]
    ds_read_b64_tr_b16 a[72:73], v56 offset:2048
    ds_read_b64_tr_b16 a[74:75], v56 offset:3072
    v_mfma_f32_16x16x32_bf16 v[84:87], a[172:175], v[24:27], v[84:87]
    ds_read_b64_tr_b16 a[76:77], v57 offset:2048
    ds_read_b64_tr_b16 a[78:79], v57 offset:3072
    v_mfma_f32_16x16x32_bf16 v[88:91], a[160:163], v[112:115], 0
    ds_read_b64_tr_b16 a[80:81], v56 offset:4096
    ds_read_b64_tr_b16 a[82:83], v56 offset:5120
    v_mfma_f32_16x16x32_bf16 v[92:95], a[164:167], v[112:115], 0
    ds_read_b64_tr_b16 a[84:85], v57 offset:4096
    ds_read_b64_tr_b16 a[86:87], v57 offset:5120
    v_mfma_f32_16x16x32_bf16 v[88:91], a[168:171], v[116:119], v[88:91]
    ds_read_b64_tr_b16 a[88:89], v56 offset:6144
    ds_read_b64_tr_b16 a[90:91], v56 offset:7168
    v_mfma_f32_16x16x32_bf16 v[92:95], a[172:175], v[116:119], v[92:95]
    ds_read_b64_tr_b16 a[92:93], v57 offset:6144
    ds_read_b64_tr_b16 a[94:95], v57 offset:7168
    s_waitcnt lgkmcnt(0)
    s_add_u32 m0, s24, 0
    s_lshl4_add_u32 s12, s22, s23
    buffer_load_dwordx4 v40, s[40:43], s12 offen offset:0 lds
    ds_read_b64_tr_b16 a[96:97], v56 offset:16384
    ds_read_b64_tr_b16 a[98:99], v56 offset:17408
    ds_read_b64_tr_b16 a[100:101], v57 offset:16384
    ds_read_b64_tr_b16 a[102:103], v57 offset:17408
    buffer_load_dwordx4 v41, s[40:43], s12 offen offset:1024 lds
    ds_read_b64_tr_b16 a[104:105], v56 offset:18432
    ds_read_b64_tr_b16 a[106:107], v56 offset:19456
    ds_read_b64_tr_b16 a[108:109], v57 offset:18432
    ds_read_b64_tr_b16 a[110:111], v57 offset:19456
    buffer_load_dwordx4 v42, s[40:43], s12 offen offset:2048 lds
    ds_read_b64_tr_b16 a[112:113], v56 offset:20480
    ds_read_b64_tr_b16 a[114:115], v56 offset:21504
    ds_read_b64_tr_b16 a[116:117], v57 offset:20480
    ds_read_b64_tr_b16 a[118:119], v57 offset:21504
    buffer_load_dwordx4 v43, s[40:43], s12 offen offset:3072 lds
    ds_read_b64_tr_b16 a[120:121], v56 offset:22528
    ds_read_b64_tr_b16 a[122:123], v56 offset:23552
    ds_read_b64_tr_b16 a[124:125], v57 offset:22528
    ds_read_b64_tr_b16 a[126:127], v57 offset:23552
    s_add_u32 m0, s24, 4096
    s_add_u32 s12, s12, 0x8000
    buffer_load_dwordx4 v40, s[40:43], s12 offen offset:0 lds
    v_cvt_pk_bf16_f32 v28, v80, v84
    ds_write_b32 v47, v28 offset:0
    v_cvt_pk_bf16_f32 v29, v81, v85
    ds_write_b32 v47, v29 offset:256
    v_cvt_pk_bf16_f32 v30, v82, v86
    buffer_load_dwordx4 v41, s[40:43], s12 offen offset:1024 lds
    ds_write_b32 v47, v30 offset:512
    v_cvt_pk_bf16_f32 v31, v83, v87
    ds_write_b32 v47, v31 offset:768
    v_cvt_pk_bf16_f32 v32, v88, v92
    buffer_load_dwordx4 v42, s[40:43], s12 offen offset:2048 lds
    ds_write_b32 v47, v32 offset:4096
    v_cvt_pk_bf16_f32 v33, v89, v93
    ds_write_b32 v47, v33 offset:4352
    v_cvt_pk_bf16_f32 v34, v90, v94
    buffer_load_dwordx4 v43, s[40:43], s12 offen offset:3072 lds
    ds_write_b32 v47, v34 offset:4608
    v_cvt_pk_bf16_f32 v35, v91, v95
    ds_write_b32 v47, v35 offset:4864
    v_add_u32 v1, s84, v61
    s_waitcnt lgkmcnt(0)
    s_barrier
    ds_read_b128 v[240:243], v1 offset:0
    ds_read_b128 v[244:247], v1 offset:1024
    v_and_b32 v2, 31, v0
    v_lshl_add_u32 v38, v2, 6, s9
    s_waitcnt lgkmcnt(1)
    buffer_store_dwordx4 v[240:243], v46, s[44:47], s7 offen sc1
    s_add_u32 s7, s7, 0x40000
    s_waitcnt lgkmcnt(0)
    buffer_store_dwordx4 v[244:247], v46, s[44:47], s7 offen sc1
    buffer_load_dwordx4 v[248:251], v39, s[32:35], 0 offen offset:0
    buffer_load_dwordx4 v[252:255], v39, s[32:35], 0 offen offset:32
    buffer_load_dword v51, v50, s[44:47], 0 offen sc1
    s_lshl_b32 s3, s72, 7
    s_add_u32 s3, s3, 137216
    v_lshl_add_u32 v1, v60, 4, s3
    ds_read_b128 v[64:67], v1 offset:0
    ds_read_b128 v[68:71], v1 offset:32
    ds_read_b128 v[72:75], v1 offset:64
    ds_read_b128 v[76:79], v1 offset:96
    s_waitcnt vmcnt(21)
    ds_read_b64_tr_b16 a[128:129], v44 offset:0
    ds_read_b64_tr_b16 a[130:131], v44 offset:1024
    ds_read_b64_tr_b16 a[132:133], v45 offset:0
    ds_read_b64_tr_b16 a[134:135], v45 offset:1024
    ds_read_b64_tr_b16 a[136:137], v44 offset:2048
    ds_read_b64_tr_b16 a[138:139], v44 offset:3072
    ds_read_b64_tr_b16 a[140:141], v45 offset:2048
    ds_read_b64_tr_b16 a[142:143], v45 offset:3072
    ds_read_b64_tr_b16 a[144:145], v44 offset:4096
    ds_read_b64_tr_b16 a[146:147], v44 offset:5120
    ds_read_b64_tr_b16 a[148:149], v45 offset:4096
    ds_read_b64_tr_b16 a[150:151], v45 offset:5120
    ds_read_b64_tr_b16 a[152:153], v44 offset:6144
    ds_read_b64_tr_b16 a[154:155], v44 offset:7168
    ds_read_b64_tr_b16 a[156:157], v45 offset:6144
    ds_read_b64_tr_b16 a[158:159], v45 offset:7168
    buffer_load_dword v58, v50, s[44:47], 0 offen sc1
    s_waitcnt vmcnt(14)
    ds_read_b64_tr_b16 a[160:161], v56 offset:32768
    ds_read_b64_tr_b16 a[162:163], v56 offset:33792
    ds_read_b64_tr_b16 a[164:165], v57 offset:32768
    ds_read_b64_tr_b16 a[166:167], v57 offset:33792
    ds_read_b64_tr_b16 a[168:169], v56 offset:34816
    ds_read_b64_tr_b16 a[170:171], v56 offset:35840
    ds_read_b64_tr_b16 a[172:173], v57 offset:34816
    ds_read_b64_tr_b16 a[174:175], v57 offset:35840
    ds_read_b64_tr_b16 a[176:177], v56 offset:36864
    ds_read_b64_tr_b16 a[178:179], v56 offset:37888
    ds_read_b64_tr_b16 a[180:181], v57 offset:36864
    ds_read_b64_tr_b16 a[182:183], v57 offset:37888
    ds_read_b64_tr_b16 a[184:185], v56 offset:38912
    ds_read_b64_tr_b16 a[186:187], v56 offset:39936
    ds_read_b64_tr_b16 a[188:189], v57 offset:38912
    ds_read_b64_tr_b16 a[190:191], v57 offset:39936
    s_cmp_eq_u32 s5, 1
    s_mov_b32 s3, 0xba000000
    s_cselect_b32 s3, 0x3a000000, s3
    v_cvt_f32_u32 v52, v38
    v_mul_f32 v52, s3, v52
    v_lshlrev_b32 v1, 1, v60
    v_cvt_f32_u32 v1, v1
    v_mul_f32 v53, v1, v52
    s_waitcnt vmcnt(1)
    v_cmp_ne_u32 vcc, s25, v51
    s_nop 1
    s_cbranch_vccnz L_h_slow
L_h_ready:
    buffer_load_dwordx4 v[128:131], v36, s[44:47], s16 offen offset:0 sc1
    buffer_load_dwordx4 v[132:135], v37, s[44:47], s16 offen offset:0 sc1
    buffer_load_dwordx4 v[136:139], v36, s[44:47], s16 offen offset:1024 sc1
    buffer_load_dwordx4 v[140:143], v37, s[44:47], s16 offen offset:1024 sc1
    buffer_load_dwordx4 v[144:147], v36, s[44:47], s16 offen offset:2048 sc1
    buffer_load_dwordx4 v[148:151], v37, s[44:47], s16 offen offset:2048 sc1
    buffer_load_dwordx4 v[152:155], v36, s[44:47], s16 offen offset:3072 sc1
    buffer_load_dwordx4 v[156:159], v37, s[44:47], s16 offen offset:3072 sc1
    buffer_load_dwordx4 v[160:163], v36, s[44:47], s17 offen offset:0 sc1
    buffer_load_dwordx4 v[164:167], v37, s[44:47], s17 offen offset:0 sc1
    buffer_load_dwordx4 v[168:171], v36, s[44:47], s17 offen offset:1024 sc1
    buffer_load_dwordx4 v[172:175], v37, s[44:47], s17 offen offset:1024 sc1
    v_lshl_add_u32 v1, v0, 2, s8
    s_mov_b64 exec, 0xffff
    buffer_store_dword v49, v1, s[44:47], 0 offen sc1
    s_nop 0
    s_mov_b64 exec, -1
    ds_read_b64_tr_b16 a[192:193], v56 offset:0
    ds_read_b64_tr_b16 a[194:195], v56 offset:1024
    ds_read_b64_tr_b16 a[196:197], v57 offset:0
    ds_read_b64_tr_b16 a[198:199], v57 offset:1024
    ds_read_b64_tr_b16 a[200:201], v56 offset:2048
    ds_read_b64_tr_b16 a[202:203], v56 offset:3072
    ds_read_b64_tr_b16 a[204:205], v57 offset:2048
    ds_read_b64_tr_b16 a[206:207], v57 offset:3072
    ds_read_b64_tr_b16 a[208:209], v56 offset:4096
    ds_read_b64_tr_b16 a[210:211], v56 offset:5120
    ds_read_b64_tr_b16 a[212:213], v57 offset:4096
    ds_read_b64_tr_b16 a[214:215], v57 offset:5120
    ds_read_b64_tr_b16 a[216:217], v56 offset:6144
    ds_read_b64_tr_b16 a[218:219], v56 offset:7168
    ds_read_b64_tr_b16 a[220:221], v57 offset:6144
    ds_read_b64_tr_b16 a[222:223], v57 offset:7168
    s_cmp_eq_u32 s5, 1
    s_cselect_b64 vcc, -1, 0
    v_add_u32 v3, s4, v2
    v_sub_u32 v47, 0x200, v3
    v_and_b32 v47, 0xff, v47
    v_cndmask_b32 v47, v3, v47, vcc
    s_lshr_b32 s3, s4, 4
    v_add_u32 v2, s3, v60
    v_lshrrev_b32 v38, 4, v0
    v_add_u32 v38, 1, v38
    v_lshrrev_b32 v38, 1, v38
    s_sub_u32 s3, 32, s3
    v_sub_u32 v38, s3, v38
    v_and_b32 v38, 15, v38
    v_cndmask_b32 v2, v2, v38, vcc
    s_lshr_b32 s3, s6, 3
    v_lshl_add_u32 v2, v2, 2, s3
    v_and_b32 v38, 15, v0
    v_lshl_add_u32 v2, v2, 4, v38
    v_lshlrev_b32 v2, 6, v2
    v_add_u32 v55, 7405568, v2
    s_lshl_b32 s3, s6, 16
    s_add_u32 s3, s3, 8388608
    v_lshlrev_b32 v2, 12, v60
    v_lshl_add_u32 v47, v47, 4, v2
    v_add_u32 v47, s3, v47
    v_mov_b32 v2, 1073741824
    v_cmp_eq_u32 vcc, 0, v3
    s_nop 1
    v_cndmask_b32 v54, v47, v2, vcc
    v_permlane32_swap_b32 v248, v250
    v_permlane32_swap_b32 v249, v251
    v_permlane32_swap_b32 v252, v254
    v_permlane32_swap_b32 v253, v255
    s_waitcnt vmcnt(12) lgkmcnt(15)
    v_mfma_f32_32x32x16_bf16 v[64:79], a[0:3], v[128:131], v[64:79]
    buffer_load_dwordx4 v[176:179], v36, s[44:47], s17 offen offset:2048 sc1
    buffer_load_dwordx4 v[180:183], v37, s[44:47], s17 offen offset:2048 sc1
    v_mfma_f32_32x32x16_bf16 v[80:95], a[4:7], v[128:131], 0
    v_fmamk_f32 v40, v52, 0x00000000, v53
    v_fmamk_f32 v42, v52, 0x3f800000, v53
    s_waitcnt vmcnt(13)
    v_mfma_f32_32x32x16_bf16 v[96:111], a[0:3], v[132:135], 0
    v_cos_f32 v41, v40
    v_cos_f32 v43, v42
    v_sin_f32 v40, v40
    v_mfma_f32_32x32x16_bf16 v[112:127], a[4:7], v[132:135], 0
    v_sin_f32 v42, v42
    v_cvt_pk_bf16_f32 v4, v41, v40
    v_cvt_pk_bf16_f32 v5, v43, v42
    s_waitcnt vmcnt(12)
    v_mfma_f32_32x32x16_bf16 v[64:79], a[8:11], v[136:139], v[64:79]
    buffer_load_dwordx4 v[128:131], v36, s[44:47], s17 offen offset:3072 sc1
    buffer_load_dwordx4 v[132:135], v37, s[44:47], s17 offen offset:3072 sc1
    v_mfma_f32_32x32x16_bf16 v[80:95], a[12:15], v[136:139], v[80:95]
    v_fmamk_f32 v40, v52, 0x42000000, v53
    v_fmamk_f32 v42, v52, 0x42040000, v53
    s_waitcnt vmcnt(13)
    v_mfma_f32_32x32x16_bf16 v[96:111], a[8:11], v[140:143], v[96:111]
    v_cos_f32 v41, v40
    v_cos_f32 v43, v42
    v_sin_f32 v40, v40
    v_mfma_f32_32x32x16_bf16 v[112:127], a[12:15], v[140:143], v[112:127]
    v_sin_f32 v42, v42
    v_cvt_pk_bf16_f32 v6, v41, v40
    v_cvt_pk_bf16_f32 v7, v43, v42
    s_waitcnt vmcnt(12)
    v_mfma_f32_32x32x16_bf16 v[64:79], a[16:19], v[144:147], v[64:79]
    buffer_load_dwordx4 v[136:139], v36, s[44:47], s18 offen offset:0 sc1
    buffer_load_dwordx4 v[140:143], v37, s[44:47], s18 offen offset:0 sc1
    v_mfma_f32_32x32x16_bf16 v[80:95], a[20:23], v[144:147], v[80:95]
    v_fmamk_f32 v40, v52, 0x40800000, v53
    v_fmamk_f32 v42, v52, 0x40a00000, v53
    s_waitcnt vmcnt(13)
    v_mfma_f32_32x32x16_bf16 v[96:111], a[16:19], v[148:151], v[96:111]
    v_cos_f32 v41, v40
    v_cos_f32 v43, v42
    v_sin_f32 v40, v40
    v_mfma_f32_32x32x16_bf16 v[112:127], a[20:23], v[148:151], v[112:127]
    v_sin_f32 v42, v42
    v_cvt_pk_bf16_f32 v8, v41, v40
    v_cvt_pk_bf16_f32 v9, v43, v42
    s_waitcnt vmcnt(12)
    v_mfma_f32_32x32x16_bf16 v[64:79], a[24:27], v[152:155], v[64:79]
    buffer_load_dwordx4 v[144:147], v36, s[44:47], s18 offen offset:1024 sc1
    buffer_load_dwordx4 v[148:151], v37, s[44:47], s18 offen offset:1024 sc1
    v_mfma_f32_32x32x16_bf16 v[80:95], a[28:31], v[152:155], v[80:95]
    v_fmamk_f32 v40, v52, 0x42100000, v53
    v_fmamk_f32 v42, v52, 0x42140000, v53
    s_waitcnt vmcnt(13)
    v_mfma_f32_32x32x16_bf16 v[96:111], a[24:27], v[156:159], v[96:111]
    v_cos_f32 v41, v40
    v_cos_f32 v43, v42
    v_sin_f32 v40, v40
    v_mfma_f32_32x32x16_bf16 v[112:127], a[28:31], v[156:159], v[112:127]
    v_sin_f32 v42, v42
    v_cvt_pk_bf16_f32 v10, v41, v40
    v_cvt_pk_bf16_f32 v11, v43, v42
    s_waitcnt vmcnt(12)
    v_mfma_f32_32x32x16_bf16 v[64:79], a[32:35], v[160:163], v[64:79]
    buffer_load_dwordx4 v[152:155], v36, s[44:47], s18 offen offset:2048 sc1
    buffer_load_dwordx4 v[156:159], v37, s[44:47], s18 offen offset:2048 sc1
    v_mfma_f32_32x32x16_bf16 v[80:95], a[36:39], v[160:163], v[80:95]
    v_fmamk_f32 v40, v52, 0x41000000, v53
    v_fmamk_f32 v42, v52, 0x41100000, v53
    s_waitcnt vmcnt(13)
    v_mfma_f32_32x32x16_bf16 v[96:111], a[32:35], v[164:167], v[96:111]
    v_cos_f32 v41, v40
    v_cos_f32 v43, v42
    v_sin_f32 v40, v40
    v_mfma_f32_32x32x16_bf16 v[112:127], a[36:39], v[164:167], v[112:127]
    v_sin_f32 v42, v42
    v_cvt_pk_bf16_f32 v12, v41, v40
    v_cvt_pk_bf16_f32 v13, v43, v42
    s_waitcnt vmcnt(12)
    v_mfma_f32_32x32x16_bf16 v[64:79], a[40:43], v[168:171], v[64:79]
    buffer_load_dwordx4 v[160:163], v36, s[44:47], s18 offen offset:3072 sc1
    buffer_load_dwordx4 v[164:167], v37, s[44:47], s18 offen offset:3072 sc1
    v_mfma_f32_32x32x16_bf16 v[80:95], a[44:47], v[168:171], v[80:95]
    v_fmamk_f32 v40, v52, 0x42200000, v53
    v_fmamk_f32 v42, v52, 0x42240000, v53
    s_waitcnt vmcnt(13)
    v_mfma_f32_32x32x16_bf16 v[96:111], a[40:43], v[172:175], v[96:111]
    v_cos_f32 v41, v40
    v_cos_f32 v43, v42
    v_sin_f32 v40, v40
    v_mfma_f32_32x32x16_bf16 v[112:127], a[44:47], v[172:175], v[112:127]
    v_sin_f32 v42, v42
    v_cvt_pk_bf16_f32 v14, v41, v40
    v_cvt_pk_bf16_f32 v15, v43, v42
    s_waitcnt vmcnt(11)
    v_mfma_f32_32x32x16_bf16 v[64:79], a[48:51], v[176:179], v[64:79]
    buffer_load_dwordx4 v[168:171], v36, s[44:47], s19 offen offset:0 sc1
    buffer_load_dwordx4 v[172:175], v37, s[44:47], s19 offen offset:0 sc1
    v_mfma_f32_32x32x16_bf16 v[80:95], a[52:55], v[176:179], v[80:95]
    v_fmamk_f32 v40, v52, 0x41400000, v53
    v_fmamk_f32 v42, v52, 0x41500000, v53
    s_waitcnt vmcnt(12)
    v_mfma_f32_32x32x16_bf16 v[96:111], a[48:51], v[180:183], v[96:111]
    v_cos_f32 v41, v40
    v_cos_f32 v43, v42
    v_sin_f32 v40, v40
    v_mfma_f32_32x32x16_bf16 v[112:127], a[52:55], v[180:183], v[112:127]
    v_sin_f32 v42, v42
    v_cvt_pk_bf16_f32 v16, v41, v40
    v_cvt_pk_bf16_f32 v17, v43, v42
    s_waitcnt vmcnt(11)
    v_mfma_f32_32x32x16_bf16 v[64:79], a[56:59], v[128:131], v[64:79]
    buffer_load_dwordx4 v[176:179], v36, s[44:47], s19 offen offset:1024 sc1
    buffer_load_dwordx4 v[180:183], v37, s[44:47], s19 offen offset:1024 sc1
    v_mfma_f32_32x32x16_bf16 v[80:95], a[60:63], v[128:131], v[80:95]
    v_fmamk_f32 v40, v52, 0x42300000, v53
    v_fmamk_f32 v42, v52, 0x42340000, v53
    s_waitcnt vmcnt(12)
    v_mfma_f32_32x32x16_bf16 v[96:111], a[56:59], v[132:135], v[96:111]
    v_cos_f32 v41, v40
    v_cos_f32 v43, v42
    v_sin_f32 v40, v40
    v_mfma_f32_32x32x16_bf16 v[112:127], a[60:63], v[132:135], v[112:127]
    v_sin_f32 v42, v42
    v_cvt_pk_bf16_f32 v18, v41, v40
    v_cvt_pk_bf16_f32 v19, v43, v42
    s_waitcnt vmcnt(11)
    v_mfma_f32_32x32x16_bf16 v[64:79], a[64:67], v[136:139], v[64:79]
    buffer_load_dwordx4 v[128:131], v36, s[44:47], s19 offen offset:2048 sc1
    buffer_load_dwordx4 v[132:135], v37, s[44:47], s19 offen offset:2048 sc1
    v_mfma_f32_32x32x16_bf16 v[80:95], a[68:71], v[136:139], v[80:95]
    v_fmamk_f32 v40, v52, 0x41800000, v53
    v_fmamk_f32 v42, v52, 0x41880000, v53
    s_waitcnt vmcnt(12)
    v_mfma_f32_32x32x16_bf16 v[96:111], a[64:67], v[140:143], v[96:111]
    v_cos_f32 v41, v40
    v_cos_f32 v43, v42
    v_sin_f32 v40, v40
    v_mfma_f32_32x32x16_bf16 v[112:127], a[68:71], v[140:143], v[112:127]
    v_sin_f32 v42, v42
    v_cvt_pk_bf16_f32 v20, v41, v40
    v_cvt_pk_bf16_f32 v21, v43, v42
    s_waitcnt vmcnt(11)
    v_mfma_f32_32x32x16_bf16 v[64:79], a[72:75], v[144:147], v[64:79]
    buffer_load_dwordx4 v[136:139], v36, s[44:47], s19 offen offset:3072 sc1
    buffer_load_dwordx4 v[140:143], v37, s[44:47], s19 offen offset:3072 sc1
    v_mfma_f32_32x32x16_bf16 v[80:95], a[76:79], v[144:147], v[80:95]
    v_fmamk_f32 v40, v52, 0x42400000, v53
    v_fmamk_f32 v42, v52, 0x42440000, v53
    s_waitcnt vmcnt(12)
    v_mfma_f32_32x32x16_bf16 v[96:111], a[72:75], v[148:151], v[96:111]
    v_cos_f32 v41, v40
    v_cos_f32 v43, v42
    v_sin_f32 v40, v40
    v_mfma_f32_32x32x16_bf16 v[112:127], a[76:79], v[148:151], v[112:127]
    v_sin_f32 v42, v42
    v_cvt_pk_bf16_f32 v22, v41, v40
    v_cvt_pk_bf16_f32 v23, v43, v42
    s_waitcnt vmcnt(11)
    v_mfma_f32_32x32x16_bf16 v[64:79], a[80:83], v[152:155], v[64:79]
    buffer_load_dwordx4 v[144:147], v36, s[44:47], s20 offen offset:0 sc1
    buffer_load_dwordx4 v[148:151], v37, s[44:47], s20 offen offset:0 sc1
    v_mfma_f32_32x32x16_bf16 v[80:95], a[84:87], v[152:155], v[80:95]
    v_fmamk_f32 v40, v52, 0x41a00000, v53
    v_fmamk_f32 v42, v52, 0x41a80000, v53
    s_waitcnt vmcnt(12)
    v_mfma_f32_32x32x16_bf16 v[96:111], a[80:83], v[156:159], v[96:111]
    v_cos_f32 v41, v40
    v_cos_f32 v43, v42
    v_sin_f32 v40, v40
    v_mfma_f32_32x32x16_bf16 v[112:127], a[84:87], v[156:159], v[112:127]
    v_sin_f32 v42, v42
    v_cvt_pk_bf16_f32 v24, v41, v40
    v_cvt_pk_bf16_f32 v25, v43, v42
    s_waitcnt vmcnt(11)
    v_mfma_f32_32x32x16_bf16 v[64:79], a[88:91], v[160:163], v[64:79]
    buffer_load_dwordx4 v[152:155], v36, s[44:47], s20 offen offset:1024 sc1
    buffer_load_dwordx4 v[156:159], v37, s[44:47], s20 offen offset:1024 sc1
    v_mfma_f32_32x32x16_bf16 v[80:95], a[92:95], v[160:163], v[80:95]
    v_fmamk_f32 v40, v52, 0x42500000, v53
    v_fmamk_f32 v42, v52, 0x42540000, v53
    s_waitcnt vmcnt(12)
    v_mfma_f32_32x32x16_bf16 v[96:111], a[88:91], v[164:167], v[96:111]
    v_cos_f32 v41, v40
    v_cos_f32 v43, v42
    v_sin_f32 v40, v40
    v_mfma_f32_32x32x16_bf16 v[112:127], a[92:95], v[164:167], v[112:127]
    v_sin_f32 v42, v42
    v_cvt_pk_bf16_f32 v26, v41, v40
    v_cvt_pk_bf16_f32 v27, v43, v42
    s_waitcnt vmcnt(11)
    v_mfma_f32_32x32x16_bf16 v[64:79], a[96:99], v[168:171], v[64:79]
    buffer_load_dwordx4 v[160:163], v36, s[44:47], s20 offen offset:2048 sc1
    buffer_load_dwordx4 v[164:167], v37, s[44:47], s20 offen offset:2048 sc1
    v_mfma_f32_32x32x16_bf16 v[80:95], a[100:103], v[168:171], v[80:95]
    v_fmamk_f32 v40, v52, 0x41c00000, v53
    v_fmamk_f32 v42, v52, 0x41c80000, v53
    s_waitcnt vmcnt(12)
    v_mfma_f32_32x32x16_bf16 v[96:111], a[96:99], v[172:175], v[96:111]
    v_cos_f32 v41, v40
    v_cos_f32 v43, v42
    v_sin_f32 v40, v40
    v_mfma_f32_32x32x16_bf16 v[112:127], a[100:103], v[172:175], v[112:127]
    v_sin_f32 v42, v42
    v_cvt_pk_bf16_f32 v28, v41, v40
    v_cvt_pk_bf16_f32 v29, v43, v42
    s_waitcnt vmcnt(11)
    v_mfma_f32_32x32x16_bf16 v[64:79], a[104:107], v[176:179], v[64:79]
    buffer_load_dwordx4 v[168:171], v36, s[44:47], s20 offen offset:3072 sc1
    buffer_load_dwordx4 v[172:175], v37, s[44:47], s20 offen offset:3072 sc1
    v_mfma_f32_32x32x16_bf16 v[80:95], a[108:111], v[176:179], v[80:95]
    v_fmamk_f32 v40, v52, 0x42600000, v53
    v_fmamk_f32 v42, v52, 0x42640000, v53
    s_waitcnt vmcnt(12)
    v_mfma_f32_32x32x16_bf16 v[96:111], a[104:107], v[180:183], v[96:111]
    v_cos_f32 v41, v40
    v_cos_f32 v43, v42
    v_sin_f32 v40, v40
    v_mfma_f32_32x32x16_bf16 v[112:127], a[108:111], v[180:183], v[112:127]
    v_sin_f32 v42, v42
    v_cvt_pk_bf16_f32 v30, v41, v40
    v_cvt_pk_bf16_f32 v31, v43, v42
    s_waitcnt vmcnt(11)
    v_mfma_f32_32x32x16_bf16 v[64:79], a[112:115], v[128:131], v[64:79]
    buffer_load_dwordx4 v[176:179], v36, s[44:47], s21 offen offset:0 sc1
    buffer_load_dwordx4 v[180:183], v37, s[44:47], s21 offen offset:0 sc1
    v_mfma_f32_32x32x16_bf16 v[80:95], a[116:119], v[128:131], v[80:95]
    v_fmamk_f32 v40, v52, 0x41e00000, v53
    v_fmamk_f32 v42, v52, 0x41e80000, v53
    s_waitcnt vmcnt(12)
    v_mfma_f32_32x32x16_bf16 v[96:111], a[112:115], v[132:135], v[96:111]
    v_cos_f32 v41, v40
    v_cos_f32 v43, v42
    v_sin_f32 v40, v40
    v_mfma_f32_32x32x16_bf16 v[112:127], a[116:119], v[132:135], v[112:127]
    v_sin_f32 v42, v42
    v_cvt_pk_bf16_f32 v32, v41, v40
    v_cvt_pk_bf16_f32 v33, v43, v42
    s_waitcnt vmcnt(11)
    v_mfma_f32_32x32x16_bf16 v[64:79], a[120:123], v[136:139], v[64:79]
    buffer_load_dwordx4 v[128:131], v36, s[44:47], s21 offen offset:1024 sc1
    buffer_load_dwordx4 v[132:135], v37, s[44:47], s21 offen offset:1024 sc1
    v_mfma_f32_32x32x16_bf16 v[80:95], a[124:127], v[136:139], v[80:95]
    v_fmamk_f32 v40, v52, 0x42700000, v53
    v_fmamk_f32 v42, v52, 0x42740000, v53
    s_waitcnt vmcnt(12)
    v_mfma_f32_32x32x16_bf16 v[96:111], a[120:123], v[140:143], v[96:111]
    v_cos_f32 v41, v40
    v_cos_f32 v43, v42
    v_sin_f32 v40, v40
    v_mfma_f32_32x32x16_bf16 v[112:127], a[124:127], v[140:143], v[112:127]
    v_sin_f32 v42, v42
    v_cvt_pk_bf16_f32 v34, v41, v40
    v_cvt_pk_bf16_f32 v35, v43, v42
    s_waitcnt vmcnt(11)
    v_mfma_f32_32x32x16_bf16 v[64:79], a[128:131], v[144:147], v[64:79]
    buffer_load_dwordx4 v[136:139], v36, s[44:47], s21 offen offset:2048 sc1
    buffer_load_dwordx4 v[140:143], v37, s[44:47], s21 offen offset:2048 sc1
    buffer_load_dword v51, v55, s[44:47], 0 offen sc1
    v_mfma_f32_32x32x16_bf16 v[80:95], a[132:135], v[144:147], v[80:95]
    s_waitcnt vmcnt(13)
    v_mfma_f32_32x32x16_bf16 v[96:111], a[128:131], v[148:151], v[96:111]
    v_mfma_f32_32x32x16_bf16 v[112:127], a[132:135], v[148:151], v[112:127]
    s_waitcnt vmcnt(12)
    v_mfma_f32_32x32x16_bf16 v[64:79], a[136:139], v[152:155], v[64:79]
    buffer_load_dwordx4 v[144:147], v36, s[44:47], s21 offen offset:3072 sc1
    buffer_load_dwordx4 v[148:151], v37, s[44:47], s21 offen offset:3072 sc1
    v_mfma_f32_32x32x16_bf16 v[80:95], a[140:143], v[152:155], v[80:95]
    s_waitcnt vmcnt(13)
    v_mfma_f32_32x32x16_bf16 v[96:111], a[136:139], v[156:159], v[96:111]
    v_mfma_f32_32x32x16_bf16 v[112:127], a[140:143], v[156:159], v[112:127]
    s_waitcnt vmcnt(12)
    v_mfma_f32_32x32x16_bf16 v[64:79], a[144:147], v[160:163], v[64:79]
    buffer_load_dwordx4 v[152:155], v36, s[44:47], s22 offen offset:0 sc1
    buffer_load_dwordx4 v[156:159], v37, s[44:47], s22 offen offset:0 sc1
    v_mfma_f32_32x32x16_bf16 v[80:95], a[148:151], v[160:163], v[80:95]
    s_waitcnt vmcnt(13)
    v_mfma_f32_32x32x16_bf16 v[96:111], a[144:147], v[164:167], v[96:111]
    v_mfma_f32_32x32x16_bf16 v[112:127], a[148:151], v[164:167], v[112:127]
    s_waitcnt vmcnt(12)
    v_mfma_f32_32x32x16_bf16 v[64:79], a[152:155], v[168:171], v[64:79]
    buffer_load_dwordx4 v[160:163], v36, s[44:47], s22 offen offset:1024 sc1
    buffer_load_dwordx4 v[164:167], v37, s[44:47], s22 offen offset:1024 sc1
    v_mfma_f32_32x32x16_bf16 v[80:95], a[156:159], v[168:171], v[80:95]
    s_xor_b32 s3, s72, 1
    s_lshl_b32 s3, s3, 12
    s_add_u32 s3, s3, 16384
    v_add_u32 v41, s3, v61
    s_xor_b32 s3, s72, 2
    s_waitcnt vmcnt(13)
    v_mfma_f32_32x32x16_bf16 v[96:111], a[152:155], v[172:175], v[96:111]
    s_lshl_b32 s3, s3, 12
    s_add_u32 s3, s3, 65536
    v_add_u32 v42, s3, v61
    s_xor_b32 s3, s72, 3
    s_lshl_b32 s3, s3, 12
    s_add_u32 s3, s3, 147456
    v_mfma_f32_32x32x16_bf16 v[112:127], a[156:159], v[172:175], v[112:127]
    v_add_u32 v43, s3, v61
    s_add_u32 s3, s79, 16384
    v_add_u32 v2, s3, v61
    s_add_u32 s3, s79, 147456
    v_add_u32 v3, s3, v61
    s_mov_b32 s80, 0xbfb8aa3b
    s_waitcnt vmcnt(12)
    v_mfma_f32_32x32x16_bf16 v[64:79], a[160:163], v[176:179], v[64:79]
    buffer_load_dwordx4 v[168:171], v36, s[44:47], s22 offen offset:2048 sc1
    buffer_load_dwordx4 v[172:175], v37, s[44:47], s22 offen offset:2048 sc1
    v_mfma_f32_32x32x16_bf16 v[80:95], a[164:167], v[176:179], v[80:95]
    s_waitcnt vmcnt(13)
    v_mfma_f32_32x32x16_bf16 v[96:111], a[160:163], v[180:183], v[96:111]
    v_mfma_f32_32x32x16_bf16 v[112:127], a[164:167], v[180:183], v[112:127]
    s_waitcnt vmcnt(12)
    v_mfma_f32_32x32x16_bf16 v[64:79], a[168:171], v[128:131], v[64:79]
    buffer_load_dwordx4 v[176:179], v36, s[44:47], s22 offen offset:3072 sc1
    buffer_load_dwordx4 v[180:183], v37, s[44:47], s22 offen offset:3072 sc1
    v_mfma_f32_32x32x16_bf16 v[80:95], a[172:175], v[128:131], v[80:95]
    v_lshl_add_u32 v1, s72, 6, v0
    v_lshrrev_b32 v38, 4, v1
    s_waitcnt vmcnt(13)
    v_mfma_f32_32x32x16_bf16 v[96:111], a[168:171], v[132:135], v[96:111]
    v_and_b32 v1, 15, v1
    v_lshl_add_u32 v1, v38, 5, v1
    v_mfma_f32_32x32x16_bf16 v[112:127], a[172:175], v[132:135], v[112:127]
    v_lshlrev_b32 v1, 6, v1
    s_add_u32 s26, s30, 7340032
    s_waitcnt vmcnt(12)
    v_mfma_f32_32x32x16_bf16 v[64:79], a[176:179], v[136:139], v[64:79]
    buffer_load_dword v38, v1, s[44:47], s26 offen sc1
    v_mfma_f32_32x32x16_bf16 v[80:95], a[180:183], v[136:139], v[80:95]
    s_waitcnt vmcnt(12)
    v_mfma_f32_32x32x16_bf16 v[96:111], a[176:179], v[140:143], v[96:111]
    v_mfma_f32_32x32x16_bf16 v[112:127], a[180:183], v[140:143], v[112:127]
    s_waitcnt vmcnt(11)
    v_cmp_ne_u32 vcc, s25, v51
    s_nop 1
    s_cbranch_vccnz L_z_slow
L_z_ready:
    s_mov_b32 s3, 0
    buffer_load_dwordx4 v[208:211], v54, s[44:47], s3 offen sc1
    s_mov_b32 s3, 8192
    buffer_load_dwordx4 v[212:215], v54, s[44:47], s3 offen sc1
    s_mov_b32 s3, 16384
    buffer_load_dwordx4 v[216:219], v54, s[44:47], s3 offen sc1
    s_mov_b32 s3, 24576
    buffer_load_dwordx4 v[220:223], v54, s[44:47], s3 offen sc1
    s_mov_b32 s3, 32768
    buffer_load_dwordx4 v[224:227], v54, s[44:47], s3 offen sc1
    s_mov_b32 s3, 40960
    buffer_load_dwordx4 v[228:231], v54, s[44:47], s3 offen sc1
    s_mov_b32 s3, 49152
    buffer_load_dwordx4 v[232:235], v54, s[44:47], s3 offen sc1
    s_mov_b32 s3, 57344
    buffer_load_dwordx4 v[236:239], v54, s[44:47], s3 offen sc1
    s_waitcnt vmcnt(18)
    v_mfma_f32_32x32x16_bf16 v[64:79], a[184:187], v[144:147], v[64:79]
    v_mfma_f32_32x32x16_bf16 v[80:95], a[188:191], v[144:147], v[80:95]
    s_waitcnt vmcnt(17)
    v_mfma_f32_32x32x16_bf16 v[96:111], a[184:187], v[148:151], v[96:111]
    v_mfma_f32_32x32x16_bf16 v[112:127], a[188:191], v[148:151], v[112:127]
    s_waitcnt vmcnt(16) lgkmcnt(14)
    v_mfma_f32_32x32x16_bf16 v[64:79], a[192:195], v[152:155], v[64:79]
    s_waitcnt lgkmcnt(12)
    v_mfma_f32_32x32x16_bf16 v[80:95], a[196:199], v[152:155], v[80:95]
    s_waitcnt vmcnt(15)
    v_mfma_f32_32x32x16_bf16 v[96:111], a[192:195], v[156:159], v[96:111]
    v_mfma_f32_32x32x16_bf16 v[112:127], a[196:199], v[156:159], v[112:127]
    s_waitcnt vmcnt(14) lgkmcnt(10)
    v_mfma_f32_32x32x16_bf16 v[64:79], a[200:203], v[160:163], v[64:79]
    s_waitcnt lgkmcnt(8)
    v_mfma_f32_32x32x16_bf16 v[80:95], a[204:207], v[160:163], v[80:95]
    s_waitcnt vmcnt(13)
    v_mfma_f32_32x32x16_bf16 v[96:111], a[200:203], v[164:167], v[96:111]
    v_mfma_f32_32x32x16_bf16 v[112:127], a[204:207], v[164:167], v[112:127]
    s_waitcnt vmcnt(12) lgkmcnt(4)
    v_mfma_f32_32x32x16_bf16 v[80:95], a[212:215], v[168:171], v[80:95]
    s_waitcnt vmcnt(11)
    v_mfma_f32_32x32x16_bf16 v[96:111], a[208:211], v[172:175], v[96:111]
    v_mfma_f32_32x32x16_bf16 v[112:127], a[212:215], v[172:175], v[112:127]
    v_mfma_f32_32x32x16_bf16 v[64:79], a[208:211], v[168:171], v[64:79]
    s_waitcnt vmcnt(10) lgkmcnt(0)
    v_mfma_f32_32x32x16_bf16 v[80:95], a[220:223], v[176:179], v[80:95]
    s_waitcnt vmcnt(9)
    v_mfma_f32_32x32x16_bf16 v[96:111], a[216:219], v[180:183], v[96:111]
    v_mfma_f32_32x32x16_bf16 v[112:127], a[220:223], v[180:183], v[112:127]
    v_mfma_f32_32x32x16_bf16 v[64:79], a[216:219], v[176:179], v[64:79]
    s_waitcnt vmcnt(7)
    v_mfma_f32_32x32x16_bf16 v[192:207], v[208:211], v[4:7], 0
    s_waitcnt vmcnt(6)
    v_mfma_f32_32x32x16_bf16 v[192:207], v[212:215], v[8:11], v[192:207]
    s_nop 3
    ds_write_b128 v41, v[80:83] offset:0
    ds_write_b128 v41, v[84:87] offset:1024
    s_waitcnt vmcnt(5)
    v_mfma_f32_32x32x16_bf16 v[192:207], v[216:219], v[12:15], v[192:207]
    ds_write_b128 v41, v[88:91] offset:2048
    ds_write_b128 v41, v[92:95] offset:3072
    s_waitcnt vmcnt(4)
    v_mfma_f32_32x32x16_bf16 v[192:207], v[220:223], v[16:19], v[192:207]
    ds_write_b128 v42, v[96:99] offset:0
    ds_write_b128 v42, v[100:103] offset:1024
    s_waitcnt vmcnt(3)
    v_mfma_f32_32x32x16_bf16 v[192:207], v[224:227], v[20:23], v[192:207]
    ds_write_b128 v42, v[104:107] offset:2048
    ds_write_b128 v42, v[108:111] offset:3072
    s_waitcnt vmcnt(2)
    v_mfma_f32_32x32x16_bf16 v[192:207], v[228:231], v[24:27], v[192:207]
    ds_write_b128 v43, v[112:115] offset:0
    ds_write_b128 v43, v[116:119] offset:1024
    s_waitcnt vmcnt(1)
    v_mfma_f32_32x32x16_bf16 v[192:207], v[232:235], v[28:31], v[192:207]
    ds_write_b128 v43, v[120:123] offset:2048
    ds_write_b128 v43, v[124:127] offset:3072
    s_waitcnt vmcnt(0)
    v_mfma_f32_32x32x16_bf16 v[192:207], v[236:239], v[32:35], v[192:207]
    v_lshlrev_b32 v44, 16, v248
    v_and_b32 v45, 0xffff0000, v248
    v_lshlrev_b32 v46, 16, v249
    v_and_b32 v47, 0xffff0000, v249
    v_lshlrev_b32 v48, 16, v250
    v_and_b32 v49, 0xffff0000, v250
    v_lshlrev_b32 v50, 16, v251
    v_and_b32 v51, 0xffff0000, v251
    v_lshlrev_b32 v52, 16, v252
    v_and_b32 v53, 0xffff0000, v252
    v_lshlrev_b32 v54, 16, v253
    v_and_b32 v55, 0xffff0000, v253
    v_lshlrev_b32 v56, 16, v254
    v_and_b32 v57, 0xffff0000, v254
    v_lshlrev_b32 v58, 16, v255
    v_and_b32 v59, 0xffff0000, v255
    s_cmp_eq_u32 s30, 0
    s_cbranch_scc1 L_e_check
L_e_ok:
    s_waitcnt lgkmcnt(0)
    s_barrier
    ds_read_b128 v[80:83], v2 offset:0
    ds_read_b128 v[96:99], v2 offset:49152
    ds_read_b128 v[112:115], v3 offset:0
    ds_read_b128 v[84:87], v2 offset:1024
    ds_read_b128 v[100:103], v2 offset:50176
    ds_read_b128 v[116:119], v3 offset:1024
    ds_read_b128 v[88:91], v2 offset:2048
    ds_read_b128 v[104:107], v2 offset:51200
    ds_read_b128 v[120:123], v3 offset:2048
    ds_read_b128 v[92:95], v2 offset:3072
    ds_read_b128 v[108:111], v2 offset:52224
    ds_read_b128 v[124:127], v3 offset:3072
    s_waitcnt lgkmcnt(11)
    v_pk_add_f32 v[64:65], v[64:65], v[80:81]
    v_pk_add_f32 v[66:67], v[66:67], v[82:83]
    s_waitcnt lgkmcnt(8)
    v_pk_add_f32 v[68:69], v[68:69], v[84:85]
    v_pk_add_f32 v[70:71], v[70:71], v[86:87]
    v_pk_add_f32 v[64:65], v[64:65], v[96:97]
    v_pk_add_f32 v[66:67], v[66:67], v[98:99]
    s_waitcnt lgkmcnt(7)
    v_pk_add_f32 v[68:69], v[68:69], v[100:101]
    v_pk_add_f32 v[70:71], v[70:71], v[102:103]
    v_pk_add_f32 v[64:65], v[64:65], v[112:113]
    v_pk_add_f32 v[66:67], v[66:67], v[114:115]
    s_waitcnt lgkmcnt(6)
    v_pk_add_f32 v[68:69], v[68:69], v[116:117]
    v_pk_add_f32 v[70:71], v[70:71], v[118:119]
    v_pk_mul_f32 v[4:5], v[64:65], s[80:81] op_sel_hi:[1,0]
    v_pk_mul_f32 v[6:7], v[66:67], s[80:81] op_sel_hi:[1,0]
    v_pk_mul_f32 v[8:9], v[68:69], s[80:81] op_sel_hi:[1,0]
    v_pk_mul_f32 v[10:11], v[70:71], s[80:81] op_sel_hi:[1,0]
    v_exp_f32 v4, v4
    v_exp_f32 v5, v5
    v_exp_f32 v6, v6
    v_exp_f32 v7, v7
    v_exp_f32 v8, v8
    v_exp_f32 v9, v9
    v_exp_f32 v10, v10
    v_exp_f32 v11, v11
    v_pk_add_f32 v[4:5], v[4:5], 1.0 op_sel_hi:[1,0]
    v_pk_add_f32 v[6:7], v[6:7], 1.0 op_sel_hi:[1,0]
    v_pk_add_f32 v[8:9], v[8:9], 1.0 op_sel_hi:[1,0]
    v_pk_add_f32 v[10:11], v[10:11], 1.0 op_sel_hi:[1,0]
    v_rcp_f32 v4, v4
    v_rcp_f32 v5, v5
    v_rcp_f32 v6, v6
    v_rcp_f32 v7, v7
    v_rcp_f32 v8, v8
    v_rcp_f32 v9, v9
    v_rcp_f32 v10, v10
    v_rcp_f32 v11, v11
    v_pk_mul_f32 v[4:5], v[4:5], v[64:65]
    v_pk_mul_f32 v[6:7], v[6:7], v[66:67]
    v_pk_mul_f32 v[8:9], v[8:9], v[68:69]
    v_pk_mul_f32 v[10:11], v[10:11], v[70:71]
    v_pk_fma_f32 v[4:5], v[4:5], v[192:193], v[44:45]
    v_pk_fma_f32 v[6:7], v[6:7], v[194:195], v[46:47]
    v_pk_fma_f32 v[8:9], v[8:9], v[196:197], v[48:49]
    v_pk_fma_f32 v[10:11], v[10:11], v[198:199], v[50:51]
    v_cvt_pk_bf16_f32 v20, v4, v5
    v_cvt_pk_bf16_f32 v21, v6, v7
    v_cvt_pk_bf16_f32 v22, v8, v9
    v_cvt_pk_bf16_f32 v23, v10, v11
    s_nop 0
    v_permlane32_swap_b32 v20, v22
    v_permlane32_swap_b32 v21, v23
    buffer_store_dwordx4 v[20:23], v39, s[52:55], 0 offen offset:0
    s_waitcnt lgkmcnt(5)
    v_pk_add_f32 v[72:73], v[72:73], v[88:89]
    v_pk_add_f32 v[74:75], v[74:75], v[90:91]
    s_waitcnt lgkmcnt(2)
    v_pk_add_f32 v[76:77], v[76:77], v[92:93]
    v_pk_add_f32 v[78:79], v[78:79], v[94:95]
    v_pk_add_f32 v[72:73], v[72:73], v[104:105]
    v_pk_add_f32 v[74:75], v[74:75], v[106:107]
    s_waitcnt lgkmcnt(1)
    v_pk_add_f32 v[76:77], v[76:77], v[108:109]
    v_pk_add_f32 v[78:79], v[78:79], v[110:111]
    v_pk_add_f32 v[72:73], v[72:73], v[120:121]
    v_pk_add_f32 v[74:75], v[74:75], v[122:123]
    s_waitcnt lgkmcnt(0)
    v_pk_add_f32 v[76:77], v[76:77], v[124:125]
    v_pk_add_f32 v[78:79], v[78:79], v[126:127]
    v_pk_mul_f32 v[12:13], v[72:73], s[80:81] op_sel_hi:[1,0]
    v_pk_mul_f32 v[14:15], v[74:75], s[80:81] op_sel_hi:[1,0]
    v_pk_mul_f32 v[16:17], v[76:77], s[80:81] op_sel_hi:[1,0]
    v_pk_mul_f32 v[18:19], v[78:79], s[80:81] op_sel_hi:[1,0]
    v_exp_f32 v12, v12
    v_exp_f32 v13, v13
    v_exp_f32 v14, v14
    v_exp_f32 v15, v15
    v_exp_f32 v16, v16
    v_exp_f32 v17, v17
    v_exp_f32 v18, v18
    v_exp_f32 v19, v19
    v_pk_add_f32 v[12:13], v[12:13], 1.0 op_sel_hi:[1,0]
    v_pk_add_f32 v[14:15], v[14:15], 1.0 op_sel_hi:[1,0]
    v_pk_add_f32 v[16:17], v[16:17], 1.0 op_sel_hi:[1,0]
    v_pk_add_f32 v[18:19], v[18:19], 1.0 op_sel_hi:[1,0]
    v_rcp_f32 v12, v12
    v_rcp_f32 v13, v13
    v_rcp_f32 v14, v14
    v_rcp_f32 v15, v15
    v_rcp_f32 v16, v16
    v_rcp_f32 v17, v17
    v_rcp_f32 v18, v18
    v_rcp_f32 v19, v19
    v_pk_mul_f32 v[12:13], v[12:13], v[72:73]
    v_pk_mul_f32 v[14:15], v[14:15], v[74:75]
    v_pk_mul_f32 v[16:17], v[16:17], v[76:77]
    v_pk_mul_f32 v[18:19], v[18:19], v[78:79]
    v_pk_fma_f32 v[12:13], v[12:13], v[200:201], v[52:53]
    v_pk_fma_f32 v[14:15], v[14:15], v[202:203], v[54:55]
    v_pk_fma_f32 v[16:17], v[16:17], v[204:205], v[56:57]
    v_pk_fma_f32 v[18:19], v[18:19], v[206:207], v[58:59]
    v_cvt_pk_bf16_f32 v24, v12, v13
    v_cvt_pk_bf16_f32 v25, v14, v15
    v_cvt_pk_bf16_f32 v26, v16, v17
    v_cvt_pk_bf16_f32 v27, v18, v19
    s_nop 0
    v_permlane32_swap_b32 v24, v26
    v_permlane32_swap_b32 v25, v27
    buffer_store_dwordx4 v[24:27], v39, s[52:55], 0 offen offset:32
    s_or_b32 s3, s30, s72
    s_cmp_eq_u32 s3, 0
    s_cbranch_scc1 L_e_store
L_e_done:
L_end:
    s_endpgm
L_loop3:
    ds_read_b128 v[128:131], v12 offset:0
    ds_read_b64_tr_b16 a[224:225], v16 offset:0
    ds_read_b64_tr_b16 a[226:227], v16 offset:1024
    ds_read_b64_tr_b16 a[228:229], v17 offset:0
    ds_read_b64_tr_b16 a[230:231], v17 offset:1024
    ds_read_b64_tr_b16 a[232:233], v18 offset:0
    ds_read_b64_tr_b16 a[234:235], v18 offset:1024
    s_waitcnt lgkmcnt(4)
    v_mfma_f32_32x32x16_bf16 v[64:79], a[224:227], v[128:131], 0
    ds_read_b128 v[132:135], v13 offset:0
    ds_read_b64_tr_b16 a[240:241], v16 offset:4096
    ds_read_b64_tr_b16 a[242:243], v16 offset:5120
    s_and_b32 s80, s78, 1
    s_mul_i32 s80, s80, 4
    s_mul_i32 s98, s3, 1
    s_add_u32 s80, s80, s98
    s_and_b32 s98, s77, 1
    s_waitcnt lgkmcnt(5)
    v_mfma_f32_32x32x16_bf16 v[80:95], a[228:231], v[128:131], 0
    ds_read_b64_tr_b16 a[244:245], v17 offset:4096
    ds_read_b64_tr_b16 a[246:247], v17 offset:5120
    s_mul_i32 s98, s98, 0
    s_add_u32 s80, s80, s98
    s_lshl2_add_u32 s77, s3, s77
    s_cmp_ge_u32 s80, 14
    s_cselect_b32 s98, 14, 0
    s_sub_u32 s80, s80, s98
    s_add_u32 m0, s79, 32768
    s_nop 0
    buffer_load_dwordx4 v4, s[32:35], s84 offen offset:0 lds
    buffer_load_dwordx4 v5, s[32:35], s84 offen offset:1024 lds
    s_waitcnt lgkmcnt(5)
    v_mfma_f32_32x32x16_bf16 v[96:111], a[232:235], v[128:131], 0
    ds_read_b64_tr_b16 a[248:249], v18 offset:4096
    ds_read_b64_tr_b16 a[250:251], v18 offset:5120
    buffer_load_dwordx4 v6, s[32:35], s84 offen offset:2048 lds
    s_cmp_ge_u32 s80, 7
    s_cselect_b32 s98, 7, 0
    s_sub_u32 s80, s80, s98
    s_lshl_b32 s80, s80, 2
    s_mov_b32 s98, 0x06543210
    s_mov_b32 s99, 0x654321
    v_mfma_f32_16x16x32_bf16 v[24:27], a[224:227], v[20:23], 0
    s_lshr_b64 s[98:99], s[98:99], s80
    s_bfe_u32 s3, s98, 262144
    s_lshl_b32 s16, s3, 12
    s_bfe_u32 s3, s98, 262148
    s_lshl_b32 s17, s3, 12
    s_bfe_u32 s3, s98, 262152
    s_waitcnt lgkmcnt(4)
    v_mfma_f32_32x32x16_bf16 v[64:79], a[240:243], v[132:135], v[64:79]
    ds_read_b128 v[136:139], v14 offset:0
    ds_read_b64_tr_b16 a[224:225], v16 offset:8192
    ds_read_b64_tr_b16 a[226:227], v16 offset:9216
    s_lshl_b32 s18, s3, 12
    s_bfe_u32 s3, s98, 262156
    s_lshl_b32 s19, s3, 12
    s_bfe_u32 s3, s98, 262160
    s_lshl_b32 s20, s3, 12
    s_waitcnt lgkmcnt(5)
    v_mfma_f32_32x32x16_bf16 v[80:95], a[244:247], v[132:135], v[80:95]
    ds_read_b64_tr_b16 a[228:229], v17 offset:8192
    ds_read_b64_tr_b16 a[230:231], v17 offset:9216
    s_bfe_u32 s3, s98, 262164
    s_lshl_b32 s21, s3, 12
    s_bfe_u32 s3, s98, 262168
    s_lshl_b32 s22, s3, 12
    s_mul_i32 s23, s72, 458752
    s_lshl_b32 s3, s78, 7
    buffer_load_dwordx4 v7, s[32:35], s84 offen offset:3072 lds
    s_add_u32 m0, s79, 81920
    s_nop 0
    buffer_load_dwordx4 v8, s[36:39], s92 offen offset:0 lds
    s_waitcnt lgkmcnt(5)
    v_mfma_f32_32x32x16_bf16 v[96:111], a[248:251], v[132:135], v[96:111]
    ds_read_b64_tr_b16 a[232:233], v18 offset:8192
    ds_read_b64_tr_b16 a[234:235], v18 offset:9216
    buffer_load_dwordx4 v9, s[36:39], s92 offen offset:1024 lds
    s_add_u32 s23, s23, s3
    v_lshrrev_b32 v1, 3, v0
    v_lshlrev_b32 v55, 10, v1
    v_lshlrev_b32 v56, 2, v52
    v_and_b32 v57, 7, v0
    v_mfma_f32_16x16x32_bf16 v[24:27], a[240:243], v[20:23], v[24:27]
    v_xor_b32 v56, v56, v57
    v_lshl_add_u32 v40, v56, 4, v55
    v_add_u32 v41, 7168, v40
    v_add_u32 v42, 14336, v40
    v_add_u32 v43, 21504, v40
    s_lshl_b32 s15, s72, 13
    s_waitcnt lgkmcnt(4)
    v_mfma_f32_32x32x16_bf16 v[64:79], a[224:227], v[136:139], v[64:79]
    ds_read_b128 v[140:143], v15 offset:0
    ds_read_b64_tr_b16 a[240:241], v16 offset:12288
    ds_read_b64_tr_b16 a[242:243], v16 offset:13312
    s_add_u32 s15, s15, 98304
    s_mov_b32 s27, s14
    s_add_u32 s98, s85, 0x80
    s_and_b32 s86, s98, 0x3ff
    s_mul_i32 s94, s86, 1792
    s_waitcnt lgkmcnt(5)
    v_mfma_f32_32x32x16_bf16 v[80:95], a[228:231], v[136:139], v[80:95]
    ds_read_b64_tr_b16 a[244:245], v17 offset:12288
    ds_read_b64_tr_b16 a[246:247], v17 offset:13312
    s_add_u32 s98, s86, 0x80
    s_and_b32 s87, s98, 0x3ff
    s_mul_i32 s95, s87, 1792
    s_add_u32 s98, s87, 0x80
    s_and_b32 s88, s98, 0x3ff
    s_add_u32 m0, s79, 81920
    s_nop 0
    buffer_load_dwordx4 v10, s[36:39], s92 offen offset:2048 lds
    s_waitcnt lgkmcnt(5)
    v_mfma_f32_32x32x16_bf16 v[96:111], a[232:235], v[136:139], v[96:111]
    ds_read_b64_tr_b16 a[248:249], v18 offset:12288
    ds_read_b64_tr_b16 a[250:251], v18 offset:13312
    buffer_load_dwordx4 v11, s[36:39], s92 offen offset:3072 lds
    s_mul_i32 s96, s88, 1792
    s_add_u32 s98, s88, 0x80
    s_and_b32 s89, s98, 0x3ff
    s_mul_i32 s97, s89, 1792
    v_lshl_add_u32 v58, v3, 2, v2
    v_mfma_f32_16x16x32_bf16 v[24:27], a[224:227], v[20:23], v[24:27]
    v_lshl_add_u32 v58, v58, 7, v54
    v_bfe_u32 v59, v0, 3, 1
    s_and_b32 s98, s72, 1
    v_xor_b32 v59, s98, v59
    v_lshl_add_u32 v58, v59, 6, v58
    s_lshl_b32 s98, s98, 13
    s_waitcnt lgkmcnt(0)
    s_waitcnt vmcnt(11)
    v_dot2_f32_bf16 v36, v28, s31, 0
    v_dot2_f32_bf16 v37, v28, v28, 0
    s_waitcnt vmcnt(10)
    v_dot2_f32_bf16 v47, v32, s31, 0
    v_dot2_f32_bf16 v63, v32, v32, 0
    v_dot2c_f32_bf16 v36, s31, v29
    v_dot2c_f32_bf16 v37, v29, v29
    v_dot2c_f32_bf16 v47, s31, v33
    v_dot2c_f32_bf16 v63, v33, v33
    v_dot2c_f32_bf16 v36, s31, v30
    v_dot2c_f32_bf16 v37, v30, v30
    v_dot2c_f32_bf16 v47, s31, v34
    v_dot2c_f32_bf16 v63, v34, v34
    v_dot2c_f32_bf16 v36, s31, v31
    v_dot2c_f32_bf16 v37, v31, v31
    v_dot2c_f32_bf16 v47, s31, v35
    v_dot2c_f32_bf16 v63, v35, v35
    v_mfma_f32_32x32x16_bf16 v[64:79], a[240:243], v[140:143], v[64:79]
    s_barrier
    ds_read_b128 v[144:147], v12 offset:16384
    ds_read_b64_tr_b16 a[224:225], v16 offset:16384
    ds_read_b64_tr_b16 a[226:227], v16 offset:17408
    s_lshr_b32 s99, s72, 1
    s_mul_i32 s24, s99, 49152
    s_add_u32 s24, s24, s98
    v_add_u32 v44, s15, v58
    v_xor_b32 v45, 64, v44
    v_mfma_f32_32x32x16_bf16 v[80:95], a[244:247], v[140:143], v[80:95]
    ds_read_b64_tr_b16 a[228:229], v17 offset:16384
    ds_read_b64_tr_b16 a[230:231], v17 offset:17408
    s_mov_b32 s80, 0xbdd2d3e8
    s_mov_b32 s81, 0xc0135761
    s_lshl_b32 s98, s76, 5
    s_lshl_b32 s99, s64, 11
    s_add_u32 s68, s99, s98
    s_lshl_b32 s99, s65, 11
    s_add_u32 m0, s79, 0
    s_nop 0
    buffer_load_dwordx4 v4, s[32:35], s85 offen offset:0 lds
    v_mfma_f32_32x32x16_bf16 v[96:111], a[248:251], v[140:143], v[96:111]
    ds_read_b64_tr_b16 a[232:233], v18 offset:16384
    ds_read_b64_tr_b16 a[234:235], v18 offset:17408
    buffer_load_dwordx4 v5, s[32:35], s85 offen offset:1024 lds
    s_add_u32 s69, s99, s98
    s_lshl_b32 s99, s66, 11
    s_add_u32 s70, s99, s98
    s_lshl_b32 s99, s67, 11
    s_add_u32 s71, s99, s98
    v_mfma_f32_16x16x32_bf16 v[24:27], a[240:243], v[20:23], v[24:27]
    s_cmp_eq_u32 s75, 3
    s_cselect_b32 s99, 0x200, 0
    s_sub_u32 s99, 131072, s99
    v_lshl_add_u32 v58, v3, 4, s99
    v_lshl_add_u32 v49, s65, 9, v58
    v_lshl_add_u32 v50, s66, 9, v58
    v_lshl_add_u32 v51, s67, 9, v58
    s_waitcnt lgkmcnt(4)
    v_mfma_f32_32x32x16_bf16 v[64:79], a[224:227], v[144:147], v[64:79]
    ds_read_b128 v[148:151], v13 offset:16384
    ds_read_b64_tr_b16 a[240:241], v16 offset:20480
    ds_read_b64_tr_b16 a[242:243], v16 offset:21504
    s_lshl_b32 s99, s72, 9
    s_add_u32 s99, s99, 131072
    v_lshl_add_u32 v48, v3, 4, s99
    s_or_b32 s98, s73, s74
    s_cmp_eq_u32 s98, 0
    s_cselect_b32 s30, 0, 1073741824
    s_mul_i32 s98, s27, 114688
    v_add_u32 v46, s98, v61
    s_waitcnt lgkmcnt(5)
    v_mfma_f32_32x32x16_bf16 v[80:95], a[228:231], v[144:147], v[80:95]
    ds_read_b64_tr_b16 a[244:245], v17 offset:20480
    ds_read_b64_tr_b16 a[246:247], v17 offset:21504
    v_and_b32 v58, 0x30, v0
    v_bfe_u32 v59, v0, 2, 1
    v_lshl_add_u32 v58, v59, 6, v58
    s_lshl_b32 s98, s72, 9
    s_add_u32 s98, s98, 131072
    v_add_u32 v60, s98, v58
    s_and_b32 s3, s72, 1
    s_lshl1_add_u32 s4, s78, s3
    s_add_u32 m0, s79, 0
    s_nop 0
    buffer_load_dwordx4 v6, s[32:35], s85 offen offset:2048 lds
    s_waitcnt lgkmcnt(5)
    v_mfma_f32_32x32x16_bf16 v[96:111], a[232:235], v[144:147], v[96:111]
    ds_read_b64_tr_b16 a[248:249], v18 offset:20480
    ds_read_b64_tr_b16 a[250:251], v18 offset:21504
    buffer_load_dwordx4 v7, s[32:35], s85 offen offset:3072 lds
    s_lshl_b32 s4, s4, 5
    s_lshr_b32 s3, s72, 1
    s_lshl_b32 s3, s3, 5
    s_add_u32 s9, s3, s77
    s_lshl4_add_u32 s3, s27, s74
    s_lshl_b32 s3, s3, 6
    v_readfirstlane_b32 s25, v39
    v_mfma_f32_16x16x32_bf16 v[24:27], a[224:227], v[20:23], v[24:27]
    v_permlane32_swap_b32 v36, v47
    v_permlane32_swap_b32 v37, v63
    s_add_u32 s25, s25, 2654435769
    v_add_f32 v36, v36, v47
    v_add_f32 v37, v37, v63
    v_mov_b32 v29, s25
    v_add_f32_dpp v36, v36, v36 row_shr:1 row_mask:0xf bank_mask:0xf bound_ctrl:0
    v_add_f32_dpp v37, v37, v37 row_shr:1 row_mask:0xf bank_mask:0xf bound_ctrl:0
    s_waitcnt lgkmcnt(4)
    v_mfma_f32_32x32x16_bf16 v[64:79], a[240:243], v[148:151], v[64:79]
    ds_read_b128 v[152:155], v14 offset:16384
    ds_read_b64_tr_b16 a[224:225], v16 offset:24576
    ds_read_b64_tr_b16 a[226:227], v16 offset:25600
    s_add_u32 s48, s3, 7340032
    s_lshl_b32 s7, s72, 19
    s_lshl4_add_u32 s3, s73, s74
    s_lshl_b32 s3, s3, 8
    s_add_u32 s7, s7, s3
    s_add_u32 s7, s7, 8388608
    s_lshl2_add_u32 s3, s74, s72
    s_waitcnt lgkmcnt(5)
    v_mfma_f32_32x32x16_bf16 v[80:95], a[244:247], v[148:151], v[80:95]
    ds_read_b64_tr_b16 a[228:229], v17 offset:24576
    ds_read_b64_tr_b16 a[230:231], v17 offset:25600
    s_lshl4_add_u32 s3, s3, s73
    s_lshl_b32 s3, s3, 6
    s_add_u32 s8, s3, 7405568
    s_lshl2_add_u32 s3, s77, s72
    s_lshl_b32 s3, s3, 8
    s_add_u32 s49, s3, 7340032
    s_mul_i32 s3, s72, 28672
    s_mul_i32 s50, s9, 114688
    s_add_u32 m0, s79, 49152
    s_nop 0
    buffer_load_dwordx4 v8, s[36:39], s93 offen offset:0 lds
    s_waitcnt lgkmcnt(5)
    v_mfma_f32_32x32x16_bf16 v[96:111], a[248:251], v[148:151], v[96:111]
    ds_read_b64_tr_b16 a[232:233], v18 offset:24576
    ds_read_b64_tr_b16 a[234:235], v18 offset:25600
    buffer_load_dwordx4 v9, s[36:39], s93 offen offset:1024 lds
    s_add_u32 s50, s50, s3
    s_xor_b32 s51, s9, 32
    s_mul_i32 s51, s51, 114688
    s_add_u32 s51, s51, s3
    s_sub_u32 s3, 32, s77
    s_and_b32 s3, s3, 31
    s_cmp_ge_u32 s78, 4
    s_cselect_b32 s6, s3, s77
    s_cselect_b32 s5, 1, 0
    v_mov_b32 v31, s25
    v_mfma_f32_16x16x32_bf16 v[24:27], a[240:243], v[20:23], v[24:27]
    v_add_f32_dpp v36, v36, v36 row_shr:2 row_mask:0xf bank_mask:0xf bound_ctrl:0
    v_add_f32_dpp v37, v37, v37 row_shr:2 row_mask:0xf bank_mask:0xf bound_ctrl:0
    v_lshlrev_b32 v32, 4, v3
    v_add_f32_dpp v36, v36, v36 row_shr:4 row_mask:0xf bank_mask:0xf bound_ctrl:0
    v_add_f32_dpp v37, v37, v37 row_shr:4 row_mask:0xf bank_mask:0xf bound_ctrl:0
    s_lshl4_add_u32 s26, s14, s74
    v_add_f32_dpp v36, v36, v36 row_shr:8 row_mask:0xf bank_mask:0xf bound_ctrl:0
    v_add_f32_dpp v37, v37, v37 row_shr:8 row_mask:0xf bank_mask:0xf bound_ctrl:0
    s_waitcnt lgkmcnt(4)
    v_mfma_f32_32x32x16_bf16 v[64:79], a[224:227], v[152:155], v[64:79]
    ds_read_b128 v[156:159], v15 offset:16384
    ds_read_b64_tr_b16 a[240:241], v16 offset:28672
    ds_read_b64_tr_b16 a[242:243], v16 offset:29696
    s_lshl_b32 s26, s26, 5
    v_add_f32_dpp v36, v36, v36 row_bcast:15 row_mask:0xa bank_mask:0xf
    s_waitcnt lgkmcnt(5)
    v_mfma_f32_32x32x16_bf16 v[80:95], a[228:231], v[152:155], v[80:95]
    ds_read_b64_tr_b16 a[244:245], v17 offset:28672
    ds_read_b64_tr_b16 a[246:247], v17 offset:29696
    v_add_f32_dpp v37, v37, v37 row_bcast:15 row_mask:0xa bank_mask:0xf
    s_add_u32 s26, s26, 7602176
    s_add_u32 m0, s79, 49152
    s_nop 0
    buffer_load_dwordx4 v10, s[36:39], s93 offen offset:2048 lds
    s_waitcnt lgkmcnt(5)
    v_mfma_f32_32x32x16_bf16 v[96:111], a[232:235], v[152:155], v[96:111]
    ds_read_b64_tr_b16 a[248:249], v18 offset:28672
    ds_read_b64_tr_b16 a[250:251], v18 offset:29696
    buffer_load_dwordx4 v11, s[36:39], s93 offen offset:3072 lds
    v_mul_f32 v28, 0x3b000000, v36
    v_mul_f32 v37, 0x3b000000, v37
    v_mfma_f32_16x16x32_bf16 v[24:27], a[224:227], v[20:23], v[24:27]
    v_fma_f32 v30, -v28, v28, v37
    v_max_f32 v30, 0, v30
    s_mov_b32 exec_lo, 0x80000000
    s_mov_b32 exec_hi, 0x80000000
    buffer_store_dwordx4 v[28:31], v32, s[44:47], s26 offen sc1
    s_mov_b64 exec, -1
    s_waitcnt lgkmcnt(0)
    v_mfma_f32_32x32x16_bf16 v[64:79], a[240:243], v[156:159], v[64:79]
    s_waitcnt vmcnt(9)
    s_barrier
    ds_read_b128 v[160:163], v12 offset:32768
    ds_read_b64_tr_b16 a[224:225], v16 offset:32768
    ds_read_b64_tr_b16 a[226:227], v16 offset:33792
    v_mfma_f32_32x32x16_bf16 v[80:95], a[244:247], v[156:159], v[80:95]
    ds_read_b64_tr_b16 a[228:229], v17 offset:32768
    s_add_u32 m0, s79, 16384
    ds_read_b64_tr_b16 a[230:231], v17 offset:33792
    buffer_load_dwordx4 v4, s[32:35], s86 offen offset:0 lds
    v_mfma_f32_32x32x16_bf16 v[96:111], a[248:251], v[156:159], v[96:111]
    ds_read_b64_tr_b16 a[232:233], v18 offset:32768
    ds_read_b64_tr_b16 a[234:235], v18 offset:33792
    buffer_load_dwordx4 v5, s[32:35], s86 offen offset:1024 lds
    v_mfma_f32_16x16x32_bf16 v[24:27], a[240:243], v[20:23], v[24:27]
    s_waitcnt lgkmcnt(4)
    v_mfma_f32_32x32x16_bf16 v[64:79], a[224:227], v[160:163], v[64:79]
    ds_read_b128 v[164:167], v13 offset:32768
    ds_read_b64_tr_b16 a[240:241], v16 offset:36864
    ds_read_b64_tr_b16 a[242:243], v16 offset:37888
    s_waitcnt lgkmcnt(5)
    v_mfma_f32_32x32x16_bf16 v[80:95], a[228:231], v[160:163], v[80:95]
    ds_read_b64_tr_b16 a[244:245], v17 offset:36864
    s_add_u32 m0, s79, 16384
    ds_read_b64_tr_b16 a[246:247], v17 offset:37888
    buffer_load_dwordx4 v6, s[32:35], s86 offen offset:2048 lds
    s_waitcnt lgkmcnt(5)
    v_mfma_f32_32x32x16_bf16 v[96:111], a[232:235], v[160:163], v[96:111]
    ds_read_b64_tr_b16 a[248:249], v18 offset:36864
    ds_read_b64_tr_b16 a[250:251], v18 offset:37888
    buffer_load_dwordx4 v7, s[32:35], s86 offen offset:3072 lds
    v_mfma_f32_16x16x32_bf16 v[24:27], a[224:227], v[20:23], v[24:27]
    s_waitcnt lgkmcnt(4)
    v_mfma_f32_32x32x16_bf16 v[64:79], a[240:243], v[164:167], v[64:79]
    ds_read_b128 v[168:171], v14 offset:32768
    ds_read_b64_tr_b16 a[224:225], v16 offset:40960
    ds_read_b64_tr_b16 a[226:227], v16 offset:41984
    s_waitcnt lgkmcnt(5)
    v_mfma_f32_32x32x16_bf16 v[80:95], a[244:247], v[164:167], v[80:95]
    ds_read_b64_tr_b16 a[228:229], v17 offset:40960
    s_add_u32 m0, s79, 65536
    ds_read_b64_tr_b16 a[230:231], v17 offset:41984
    buffer_load_dwordx4 v8, s[36:39], s94 offen offset:0 lds
    s_waitcnt lgkmcnt(5)
    v_mfma_f32_32x32x16_bf16 v[96:111], a[248:251], v[164:167], v[96:111]
    ds_read_b64_tr_b16 a[232:233], v18 offset:40960
    ds_read_b64_tr_b16 a[234:235], v18 offset:41984
    buffer_load_dwordx4 v9, s[36:39], s94 offen offset:1024 lds
    v_mfma_f32_16x16x32_bf16 v[24:27], a[240:243], v[20:23], v[24:27]
    s_waitcnt lgkmcnt(4)
    v_mfma_f32_32x32x16_bf16 v[64:79], a[224:227], v[168:171], v[64:79]
    ds_read_b128 v[172:175], v15 offset:32768
    ds_read_b64_tr_b16 a[240:241], v16 offset:45056
    ds_read_b64_tr_b16 a[242:243], v16 offset:46080
    s_waitcnt lgkmcnt(5)
    v_mfma_f32_32x32x16_bf16 v[80:95], a[228:231], v[168:171], v[80:95]
    ds_read_b64_tr_b16 a[244:245], v17 offset:45056
    s_add_u32 m0, s79, 65536
    ds_read_b64_tr_b16 a[246:247], v17 offset:46080
    buffer_load_dwordx4 v10, s[36:39], s94 offen offset:2048 lds
    s_waitcnt lgkmcnt(5)
    v_mfma_f32_32x32x16_bf16 v[96:111], a[232:235], v[168:171], v[96:111]
    ds_read_b64_tr_b16 a[248:249], v18 offset:45056
    ds_read_b64_tr_b16 a[250:251], v18 offset:46080
    buffer_load_dwordx4 v11, s[36:39], s94 offen offset:3072 lds
    v_mfma_f32_16x16x32_bf16 v[24:27], a[224:227], v[20:23], v[24:27]
    s_waitcnt lgkmcnt(0)
    v_mfma_f32_32x32x16_bf16 v[64:79], a[240:243], v[172:175], v[64:79]
    s_waitcnt vmcnt(9)
    s_barrier
    ds_read_b128 v[176:179], v12 offset:0
    ds_read_b64_tr_b16 a[224:225], v16 offset:0
    ds_read_b64_tr_b16 a[226:227], v16 offset:1024
    v_mfma_f32_32x32x16_bf16 v[80:95], a[244:247], v[172:175], v[80:95]
    ds_read_b64_tr_b16 a[228:229], v17 offset:0
    s_add_u32 m0, s79, 32768
    ds_read_b64_tr_b16 a[230:231], v17 offset:1024
    buffer_load_dwordx4 v4, s[32:35], s87 offen offset:0 lds
    v_mfma_f32_32x32x16_bf16 v[96:111], a[248:251], v[172:175], v[96:111]
    ds_read_b64_tr_b16 a[232:233], v18 offset:0
    ds_read_b64_tr_b16 a[234:235], v18 offset:1024
    buffer_load_dwordx4 v5, s[32:35], s87 offen offset:1024 lds
    v_mfma_f32_16x16x32_bf16 v[24:27], a[240:243], v[20:23], v[24:27]
    s_waitcnt lgkmcnt(4)
    v_mfma_f32_32x32x16_bf16 v[64:79], a[224:227], v[176:179], v[64:79]
    ds_read_b128 v[180:183], v13 offset:0
    ds_read_b64_tr_b16 a[240:241], v16 offset:4096
    ds_read_b64_tr_b16 a[242:243], v16 offset:5120
    s_lshr_b32 s12, s2, 5
    s_and_b32 s13, s2, 7
    s_waitcnt lgkmcnt(5)
    v_mfma_f32_32x32x16_bf16 v[80:95], a[228:231], v[176:179], v[80:95]
    ds_read_b64_tr_b16 a[244:245], v17 offset:4096
    ds_read_b64_tr_b16 a[246:247], v17 offset:5120
    s_lshl3_add_u32 s13, s12, s13
    s_lshl2_add_u32 s13, s13, s72
    s_add_u32 m0, s79, 32768
    s_nop 0
    buffer_load_dwordx4 v6, s[32:35], s87 offen offset:2048 lds
    s_waitcnt lgkmcnt(5)
    v_mfma_f32_32x32x16_bf16 v[96:111], a[232:235], v[176:179], v[96:111]
    ds_read_b64_tr_b16 a[248:249], v18 offset:4096
    ds_read_b64_tr_b16 a[250:251], v18 offset:5120
    buffer_load_dwordx4 v7, s[32:35], s87 offen offset:3072 lds
    s_mul_i32 s12, s13, 7168
    s_cmp_eq_u32 s75, 2
    s_cselect_b32 s12, s12, 1073741824
    v_mfma_f32_16x16x32_bf16 v[24:27], a[224:227], v[20:23], v[24:27]
    v_min_u32 v39, 55, v0
    v_lshlrev_b32 v39, 7, v39
    buffer_load_dword a0, v39, s[40:43], s12 offen
    s_waitcnt lgkmcnt(4)
    v_mfma_f32_32x32x16_bf16 v[64:79], a[240:243], v[180:183], v[64:79]
    ds_read_b128 v[184:187], v14 offset:0
    ds_read_b64_tr_b16 a[224:225], v16 offset:8192
    ds_read_b64_tr_b16 a[226:227], v16 offset:9216
    s_waitcnt lgkmcnt(5)
    v_mfma_f32_32x32x16_bf16 v[80:95], a[244:247], v[180:183], v[80:95]
    ds_read_b64_tr_b16 a[228:229], v17 offset:8192
    s_add_u32 m0, s79, 81920
    ds_read_b64_tr_b16 a[230:231], v17 offset:9216
    buffer_load_dwordx4 v8, s[36:39], s95 offen offset:0 lds
    s_waitcnt lgkmcnt(5)
    v_mfma_f32_32x32x16_bf16 v[96:111], a[248:251], v[180:183], v[96:111]
    ds_read_b64_tr_b16 a[232:233], v18 offset:8192
    ds_read_b64_tr_b16 a[234:235], v18 offset:9216
    buffer_load_dwordx4 v9, s[36:39], s95 offen offset:1024 lds
    v_mfma_f32_16x16x32_bf16 v[24:27], a[240:243], v[20:23], v[24:27]
    s_waitcnt lgkmcnt(4)
    v_mfma_f32_32x32x16_bf16 v[64:79], a[224:227], v[184:187], v[64:79]
    ds_read_b128 v[188:191], v15 offset:0
    ds_read_b64_tr_b16 a[240:241], v16 offset:12288
    ds_read_b64_tr_b16 a[242:243], v16 offset:13312
    s_waitcnt lgkmcnt(5)
    v_mfma_f32_32x32x16_bf16 v[80:95], a[228:231], v[184:187], v[80:95]
    ds_read_b64_tr_b16 a[244:245], v17 offset:12288
    s_add_u32 m0, s79, 81920
    ds_read_b64_tr_b16 a[246:247], v17 offset:13312
    buffer_load_dwordx4 v10, s[36:39], s95 offen offset:2048 lds
    s_waitcnt lgkmcnt(5)
    v_mfma_f32_32x32x16_bf16 v[96:111], a[232:235], v[184:187], v[96:111]
    ds_read_b64_tr_b16 a[248:249], v18 offset:12288
    ds_read_b64_tr_b16 a[250:251], v18 offset:13312
    buffer_load_dwordx4 v11, s[36:39], s95 offen offset:3072 lds
    v_mfma_f32_16x16x32_bf16 v[24:27], a[224:227], v[20:23], v[24:27]
    s_waitcnt lgkmcnt(0)
    v_mfma_f32_32x32x16_bf16 v[64:79], a[240:243], v[188:191], v[64:79]
    s_waitcnt vmcnt(9)
    s_barrier
    ds_read_b128 v[192:195], v12 offset:16384
    ds_read_b64_tr_b16 a[224:225], v16 offset:16384
    ds_read_b64_tr_b16 a[226:227], v16 offset:17408
    v_lshlrev_b32 v2, 16, v38
    v_and_b32 v1, 31, v0
    v_mfma_f32_32x32x16_bf16 v[80:95], a[244:247], v[188:191], v[80:95]
    ds_read_b64_tr_b16 a[228:229], v17 offset:16384
    ds_read_b64_tr_b16 a[230:231], v17 offset:17408
    s_lshl_b32 s98, s72, 9
    s_add_u32 s98, s98, 131072
    s_add_u32 m0, s79, 0
    v_lshl_add_u32 v38, v1, 2, s98
    buffer_load_dwordx4 v4, s[32:35], s88 offen offset:0 lds
    v_mfma_f32_32x32x16_bf16 v[96:111], a[248:251], v[188:191], v[96:111]
    ds_read_b64_tr_b16 a[232:233], v18 offset:16384
    ds_read_b64_tr_b16 a[234:235], v18 offset:17408
    buffer_load_dwordx4 v5, s[32:35], s88 offen offset:1024 lds
    ds_write_b32 v38, v2 offset:128
    v_lshlrev_b32 v53, 16, v53
    s_lshl_b32 s98, s72, 7
    v_mfma_f32_16x16x32_bf16 v[24:27], a[240:243], v[20:23], v[24:27]
    s_add_u32 s98, s98, 137216
    v_lshl_add_u32 v1, v1, 2, s98
    ds_write_b32 v1, v53
    s_waitcnt lgkmcnt(6)
    v_mfma_f32_32x32x16_bf16 v[64:79], a[224:227], v[192:195], v[64:79]
    ds_read_b128 v[196:199], v13 offset:16384
    ds_read_b64_tr_b16 a[240:241], v16 offset:20480
    ds_read_b64_tr_b16 a[242:243], v16 offset:21504
    s_lshl_b32 s82, s72, 9
    s_waitcnt lgkmcnt(7)
    v_mfma_f32_32x32x16_bf16 v[80:95], a[228:231], v[192:195], v[80:95]
    ds_read_b64_tr_b16 a[244:245], v17 offset:20480
    ds_read_b64_tr_b16 a[246:247], v17 offset:21504
    s_add_u32 s82, s82, 131328
    s_lshl2_add_u32 s83, s72, 139264
    s_add_u32 m0, s79, 0
    s_nop 0
    buffer_load_dwordx4 v6, s[32:35], s88 offen offset:2048 lds
    s_waitcnt lgkmcnt(7)
    v_mfma_f32_32x32x16_bf16 v[96:111], a[232:235], v[192:195], v[96:111]
    ds_read_b64_tr_b16 a[248:249], v18 offset:20480
    ds_read_b64_tr_b16 a[250:251], v18 offset:21504
    buffer_load_dwordx4 v7, s[32:35], s88 offen offset:3072 lds
    s_lshl_b32 s84, s72, 11
    v_mfma_f32_16x16x32_bf16 v[24:27], a[224:227], v[20:23], v[24:27]
    s_add_u32 s84, s84, 139264
    s_lshl_b32 s85, s4, 1
    s_waitcnt lgkmcnt(4)
    v_mfma_f32_32x32x16_bf16 v[64:79], a[240:243], v[196:199], v[64:79]
    ds_read_b128 v[200:203], v14 offset:16384
    ds_read_b64_tr_b16 a[224:225], v16 offset:24576
    ds_read_b64_tr_b16 a[226:227], v16 offset:25600
    v_and_b32 v47, 31, v0
    s_waitcnt lgkmcnt(5)
    v_mfma_f32_32x32x16_bf16 v[80:95], a[244:247], v[196:199], v[80:95]
    ds_read_b64_tr_b16 a[228:229], v17 offset:24576
    ds_read_b64_tr_b16 a[230:231], v17 offset:25600
    s_add_u32 m0, s79, 49152
    v_lshl_add_u32 v47, v47, 6, s9
    buffer_load_dwordx4 v8, s[36:39], s96 offen offset:0 lds
    s_waitcnt lgkmcnt(5)
    v_mfma_f32_32x32x16_bf16 v[96:111], a[248:251], v[196:199], v[96:111]
    ds_read_b64_tr_b16 a[232:233], v18 offset:24576
    ds_read_b64_tr_b16 a[234:235], v18 offset:25600
    buffer_load_dwordx4 v9, s[36:39], s96 offen offset:1024 lds
    v_lshl_add_u32 v39, v47, 10, s85
    v_mfma_f32_16x16x32_bf16 v[24:27], a[240:243], v[20:23], v[24:27]
    v_lshlrev_b32 v47, 4, v3
    v_add_u32 v39, v47, v39
    s_waitcnt lgkmcnt(4)
    v_mfma_f32_32x32x16_bf16 v[64:79], a[224:227], v[200:203], v[64:79]
    ds_read_b128 v[204:207], v15 offset:16384
    ds_read_b64_tr_b16 a[240:241], v16 offset:28672
    ds_read_b64_tr_b16 a[242:243], v16 offset:29696
    s_waitcnt lgkmcnt(5)
    v_mfma_f32_32x32x16_bf16 v[80:95], a[228:231], v[200:203], v[80:95]
    ds_read_b64_tr_b16 a[244:245], v17 offset:28672
    s_add_u32 m0, s79, 49152
    ds_read_b64_tr_b16 a[246:247], v17 offset:29696
    buffer_load_dwordx4 v10, s[36:39], s96 offen offset:2048 lds
    s_waitcnt lgkmcnt(5)
    v_mfma_f32_32x32x16_bf16 v[96:111], a[232:235], v[200:203], v[96:111]
    ds_read_b64_tr_b16 a[248:249], v18 offset:28672
    ds_read_b64_tr_b16 a[250:251], v18 offset:29696
    buffer_load_dwordx4 v11, s[36:39], s96 offen offset:3072 lds
    v_mfma_f32_16x16x32_bf16 v[24:27], a[224:227], v[20:23], v[24:27]
    s_waitcnt lgkmcnt(0)
    v_mfma_f32_32x32x16_bf16 v[64:79], a[240:243], v[204:207], v[64:79]
    s_waitcnt vmcnt(8)
    s_barrier
    ds_read_b128 v[208:211], v12 offset:32768
    ds_read_b64_tr_b16 a[224:225], v16 offset:32768
    ds_read_b64_tr_b16 a[226:227], v16 offset:33792
    v_mfma_f32_32x32x16_bf16 v[80:95], a[244:247], v[204:207], v[80:95]
    ds_read_b64_tr_b16 a[228:229], v17 offset:32768
    s_add_u32 m0, s79, 16384
    ds_read_b64_tr_b16 a[230:231], v17 offset:33792
    buffer_load_dwordx4 v4, s[32:35], s89 offen offset:0 lds
    v_mfma_f32_32x32x16_bf16 v[96:111], a[248:251], v[204:207], v[96:111]
    ds_read_b64_tr_b16 a[232:233], v18 offset:32768
    ds_read_b64_tr_b16 a[234:235], v18 offset:33792
    buffer_load_dwordx4 v5, s[32:35], s89 offen offset:1024 lds
    v_mfma_f32_16x16x32_bf16 v[24:27], a[240:243], v[20:23], v[24:27]
    s_waitcnt lgkmcnt(4)
    v_mfma_f32_32x32x16_bf16 v[64:79], a[224:227], v[208:211], v[64:79]
    ds_read_b128 v[212:215], v13 offset:32768
    ds_read_b64_tr_b16 a[240:241], v16 offset:36864
    ds_read_b64_tr_b16 a[242:243], v16 offset:37888
    s_waitcnt lgkmcnt(5)
    v_mfma_f32_32x32x16_bf16 v[80:95], a[228:231], v[208:211], v[80:95]
    ds_read_b64_tr_b16 a[244:245], v17 offset:36864
    s_add_u32 m0, s79, 16384
    ds_read_b64_tr_b16 a[246:247], v17 offset:37888
    buffer_load_dwordx4 v6, s[32:35], s89 offen offset:2048 lds
    s_waitcnt lgkmcnt(5)
    v_mfma_f32_32x32x16_bf16 v[96:111], a[232:235], v[208:211], v[96:111]
    ds_read_b64_tr_b16 a[248:249], v18 offset:36864
    ds_read_b64_tr_b16 a[250:251], v18 offset:37888
    buffer_load_dwordx4 v7, s[32:35], s89 offen offset:3072 lds
    v_mfma_f32_16x16x32_bf16 v[24:27], a[224:227], v[20:23], v[24:27]
    s_waitcnt lgkmcnt(4)
    v_mfma_f32_32x32x16_bf16 v[64:79], a[240:243], v[212:215], v[64:79]
    ds_read_b128 v[216:219], v14 offset:32768
    ds_read_b64_tr_b16 a[224:225], v16 offset:40960
    ds_read_b64_tr_b16 a[226:227], v16 offset:41984
    s_waitcnt lgkmcnt(5)
    v_mfma_f32_32x32x16_bf16 v[80:95], a[244:247], v[212:215], v[80:95]
    ds_read_b64_tr_b16 a[228:229], v17 offset:40960
    s_add_u32 m0, s79, 65536
    ds_read_b64_tr_b16 a[230:231], v17 offset:41984
    buffer_load_dwordx4 v8, s[36:39], s97 offen offset:0 lds
    s_waitcnt lgkmcnt(5)
    v_mfma_f32_32x32x16_bf16 v[96:111], a[248:251], v[212:215], v[96:111]
    ds_read_b64_tr_b16 a[232:233], v18 offset:40960
    ds_read_b64_tr_b16 a[234:235], v18 offset:41984
    buffer_load_dwordx4 v9, s[36:39], s97 offen offset:1024 lds
    v_mfma_f32_16x16x32_bf16 v[24:27], a[240:243], v[20:23], v[24:27]
    s_waitcnt lgkmcnt(4)
    v_mfma_f32_32x32x16_bf16 v[64:79], a[224:227], v[216:219], v[64:79]
    ds_read_b128 v[220:223], v15 offset:32768
    ds_read_b64_tr_b16 a[240:241], v16 offset:45056
    ds_read_b64_tr_b16 a[242:243], v16 offset:46080
    v_and_b32 v32, 31, v0
    s_waitcnt lgkmcnt(5)
    v_mfma_f32_32x32x16_bf16 v[80:95], a[228:231], v[216:219], v[80:95]
    ds_read_b64_tr_b16 a[244:245], v17 offset:45056
    ds_read_b64_tr_b16 a[246:247], v17 offset:46080
    s_add_u32 m0, s79, 65536
    v_lshlrev_b32 v32, 4, v32
    buffer_load_dwordx4 v10, s[36:39], s97 offen offset:2048 lds
    s_waitcnt lgkmcnt(5)
    v_mfma_f32_32x32x16_bf16 v[96:111], a[232:235], v[216:219], v[96:111]
    ds_read_b64_tr_b16 a[248:249], v18 offset:45056
    ds_read_b64_tr_b16 a[250:251], v18 offset:46080
    buffer_load_dwordx4 v11, s[36:39], s97 offen offset:3072 lds
    s_lshl_b32 s26, s14, 9
    v_mfma_f32_16x16x32_bf16 v[24:27], a[224:227], v[20:23], v[24:27]
    s_add_u32 s26, s26, 7602176
    buffer_load_dwordx4 v[28:31], v32, s[44:47], s26 offen sc1
    s_waitcnt lgkmcnt(0)
    v_mfma_f32_32x32x16_bf16 v[64:79], a[240:243], v[220:223], v[64:79]
    s_waitcnt vmcnt(9)
    s_barrier
    ds_read_b128 v[224:227], v12 offset:0
    ds_read_b64_tr_b16 a[224:225], v16 offset:0
    ds_read_b64_tr_b16 a[226:227], v16 offset:1024
    v_mfma_f32_32x32x16_bf16 v[80:95], a[244:247], v[220:223], v[80:95]
    ds_read_b64_tr_b16 a[228:229], v17 offset:0
    ds_read_b64_tr_b16 a[230:231], v17 offset:1024
    s_add_u32 m0, s15, 0
    s_lshl4_add_u32 s12, s16, s23
    buffer_load_dwordx4 v40, s[40:43], s12 offen offset:0 lds
    v_mfma_f32_32x32x16_bf16 v[96:111], a[248:251], v[220:223], v[96:111]
    ds_read_b64_tr_b16 a[232:233], v18 offset:0
    ds_read_b64_tr_b16 a[234:235], v18 offset:1024
    buffer_load_dwordx4 v41, s[40:43], s12 offen offset:1024 lds
    v_mfma_f32_16x16x32_bf16 v[24:27], a[240:243], v[20:23], v[24:27]
    s_waitcnt lgkmcnt(4)
    v_mfma_f32_32x32x16_bf16 v[64:79], a[224:227], v[224:227], v[64:79]
    ds_read_b128 v[228:231], v13 offset:0
    ds_read_b64_tr_b16 a[240:241], v16 offset:4096
    ds_read_b64_tr_b16 a[242:243], v16 offset:5120
    s_waitcnt lgkmcnt(5)
    v_mfma_f32_32x32x16_bf16 v[80:95], a[228:231], v[224:227], v[80:95]
    ds_read_b64_tr_b16 a[244:245], v17 offset:4096
    ds_read_b64_tr_b16 a[246:247], v17 offset:5120
    buffer_load_dwordx4 v42, s[40:43], s12 offen offset:2048 lds
    s_waitcnt lgkmcnt(5)
    v_mfma_f32_32x32x16_bf16 v[96:111], a[232:235], v[224:227], v[96:111]
    ds_read_b64_tr_b16 a[248:249], v18 offset:4096
    ds_read_b64_tr_b16 a[250:251], v18 offset:5120
    v_mfma_f32_16x16x32_bf16 v[24:27], a[224:227], v[20:23], v[24:27]
    s_waitcnt lgkmcnt(4)
    v_mfma_f32_32x32x16_bf16 v[64:79], a[240:243], v[228:231], v[64:79]
    ds_read_b128 v[232:235], v14 offset:0
    ds_read_b64_tr_b16 a[224:225], v16 offset:8192
    ds_read_b64_tr_b16 a[226:227], v16 offset:9216
    s_waitcnt lgkmcnt(5)
    v_mfma_f32_32x32x16_bf16 v[80:95], a[244:247], v[228:231], v[80:95]
    ds_read_b64_tr_b16 a[228:229], v17 offset:8192
    ds_read_b64_tr_b16 a[230:231], v17 offset:9216
    buffer_load_dwordx4 v43, s[40:43], s12 offen offset:3072 lds
    s_add_u32 m0, s15, 4096
    s_add_u32 s12, s12, 0x8000
    s_waitcnt lgkmcnt(5)
    v_mfma_f32_32x32x16_bf16 v[96:111], a[248:251], v[228:231], v[96:111]
    ds_read_b64_tr_b16 a[232:233], v18 offset:8192
    ds_read_b64_tr_b16 a[234:235], v18 offset:9216
    buffer_load_dwordx4 v40, s[40:43], s12 offen offset:0 lds
    v_mfma_f32_16x16x32_bf16 v[24:27], a[240:243], v[20:23], v[24:27]
    s_waitcnt lgkmcnt(4)
    v_mfma_f32_32x32x16_bf16 v[64:79], a[224:227], v[232:235], v[64:79]
    ds_read_b128 v[236:239], v15 offset:0
    ds_read_b64_tr_b16 a[240:241], v16 offset:12288
    ds_read_b64_tr_b16 a[242:243], v16 offset:13312
    s_waitcnt lgkmcnt(5)
    v_mfma_f32_32x32x16_bf16 v[80:95], a[228:231], v[232:235], v[80:95]
    ds_read_b64_tr_b16 a[244:245], v17 offset:12288
    ds_read_b64_tr_b16 a[246:247], v17 offset:13312
    buffer_load_dwordx4 v41, s[40:43], s12 offen offset:1024 lds
    s_waitcnt lgkmcnt(5)
    v_mfma_f32_32x32x16_bf16 v[96:111], a[232:235], v[232:235], v[96:111]
    ds_read_b64_tr_b16 a[248:249], v18 offset:12288
    ds_read_b64_tr_b16 a[250:251], v18 offset:13312
    v_mfma_f32_16x16x32_bf16 v[24:27], a[224:227], v[20:23], v[24:27]
    s_waitcnt lgkmcnt(0)
    v_mfma_f32_32x32x16_bf16 v[64:79], a[240:243], v[236:239], v[64:79]
    s_waitcnt vmcnt(7)
    s_barrier
    ds_read_b128 v[240:243], v12 offset:16384
    ds_read_b64_tr_b16 a[224:225], v16 offset:16384
    ds_read_b64_tr_b16 a[226:227], v16 offset:17408
    v_mfma_f32_32x32x16_bf16 v[80:95], a[244:247], v[236:239], v[80:95]
    ds_read_b64_tr_b16 a[228:229], v17 offset:16384
    ds_read_b64_tr_b16 a[230:231], v17 offset:17408
    buffer_load_dwordx4 v42, s[40:43], s12 offen offset:2048 lds
    v_mfma_f32_32x32x16_bf16 v[96:111], a[248:251], v[236:239], v[96:111]
    ds_read_b64_tr_b16 a[232:233], v18 offset:16384
    ds_read_b64_tr_b16 a[234:235], v18 offset:17408
    buffer_load_dwordx4 v43, s[40:43], s12 offen offset:3072 lds
    v_mfma_f32_16x16x32_bf16 v[24:27], a[240:243], v[20:23], v[24:27]
    s_waitcnt lgkmcnt(4)
    v_mfma_f32_32x32x16_bf16 v[64:79], a[224:227], v[240:243], v[64:79]
    ds_read_b128 v[244:247], v13 offset:16384
    ds_read_b64_tr_b16 a[240:241], v16 offset:20480
    ds_read_b64_tr_b16 a[242:243], v16 offset:21504
    s_waitcnt lgkmcnt(5)
    v_mfma_f32_32x32x16_bf16 v[80:95], a[228:231], v[240:243], v[80:95]
    ds_read_b64_tr_b16 a[244:245], v17 offset:20480
    ds_read_b64_tr_b16 a[246:247], v17 offset:21504
    s_add_u32 m0, s24, 32768
    s_lshl4_add_u32 s12, s17, s23
    s_waitcnt lgkmcnt(5)
    v_mfma_f32_32x32x16_bf16 v[96:111], a[232:235], v[240:243], v[96:111]
    ds_read_b64_tr_b16 a[248:249], v18 offset:20480
    ds_read_b64_tr_b16 a[250:251], v18 offset:21504
    buffer_load_dwordx4 v40, s[40:43], s12 offen offset:0 lds
    v_mfma_f32_16x16x32_bf16 v[24:27], a[224:227], v[20:23], v[24:27]
    s_waitcnt lgkmcnt(4)
    v_mfma_f32_32x32x16_bf16 v[64:79], a[240:243], v[244:247], v[64:79]
    ds_read_b128 v[248:251], v14 offset:16384
    ds_read_b64_tr_b16 a[224:225], v16 offset:24576
    ds_read_b64_tr_b16 a[226:227], v16 offset:25600
    s_waitcnt lgkmcnt(5)
    v_mfma_f32_32x32x16_bf16 v[80:95], a[244:247], v[244:247], v[80:95]
    ds_read_b64_tr_b16 a[228:229], v17 offset:24576
    ds_read_b64_tr_b16 a[230:231], v17 offset:25600
    buffer_load_dwordx4 v41, s[40:43], s12 offen offset:1024 lds
    s_waitcnt lgkmcnt(5)
    v_mfma_f32_32x32x16_bf16 v[96:111], a[248:251], v[244:247], v[96:111]
    ds_read_b64_tr_b16 a[232:233], v18 offset:24576
    ds_read_b64_tr_b16 a[234:235], v18 offset:25600
    buffer_load_dwordx4 v42, s[40:43], s12 offen offset:2048 lds
    v_mfma_f32_16x16x32_bf16 v[24:27], a[240:243], v[20:23], v[24:27]
    s_waitcnt lgkmcnt(4)
    v_mfma_f32_32x32x16_bf16 v[64:79], a[224:227], v[248:251], v[64:79]
    ds_read_b128 v[252:255], v15 offset:16384
    ds_read_b64_tr_b16 a[240:241], v16 offset:28672
    ds_read_b64_tr_b16 a[242:243], v16 offset:29696
    s_waitcnt lgkmcnt(5)
    v_mfma_f32_32x32x16_bf16 v[80:95], a[228:231], v[248:251], v[80:95]
    ds_read_b64_tr_b16 a[244:245], v17 offset:28672
    ds_read_b64_tr_b16 a[246:247], v17 offset:29696
    buffer_load_dwordx4 v43, s[40:43], s12 offen offset:3072 lds
    s_waitcnt lgkmcnt(5)
    v_mfma_f32_32x32x16_bf16 v[96:111], a[232:235], v[248:251], v[96:111]
    ds_read_b64_tr_b16 a[248:249], v18 offset:28672
    ds_read_b64_tr_b16 a[250:251], v18 offset:29696
    v_mfma_f32_16x16x32_bf16 v[24:27], a[224:227], v[20:23], v[24:27]
    s_waitcnt lgkmcnt(4)
    v_mfma_f32_16x16x32_bf16 v[24:27], a[240:243], v[20:23], v[24:27]
    v_mfma_f32_32x32x16_bf16 v[64:79], a[240:243], v[252:255], v[64:79]
    s_waitcnt vmcnt(12)
    v_cmp_ne_u32 s[98:99], s25, v29
    v_cmp_ne_u32 vcc, s25, v31
    s_nop 2
    s_or_b64 vcc, vcc, s[98:99]
    s_cbranch_scc1 L_st_slow3
L_st_ok3:
    s_waitcnt lgkmcnt(2)
    v_mfma_f32_32x32x16_bf16 v[80:95], a[244:247], v[252:255], v[80:95]
    v_add_f32 v3, 0x3727c5ac, v30
    v_rsq_f32 v3, v3
    s_nop 0
    v_mul_f32 v2, v30, v3
    v_fmaak_f32 v2, v2, v3, 0x3727c5ac
    s_waitcnt lgkmcnt(0)
    v_mfma_f32_32x32x16_bf16 v[96:111], a[248:251], v[252:255], v[96:111]
    v_rsq_f32 v2, v2
    ds_write_b32 v38, v3 offset:256
    v_mul_f32 v36, v2, v3
    v_mul_f32 v37, -v28, v36
    s_mov_b32 exec_lo, 0x00110011
    s_mov_b32 exec_hi, 0x00110011
    ds_write_b128 v60, v[24:27]
    s_mov_b64 exec, -1
    s_waitcnt lgkmcnt(0)
    ds_read_b128 v[4:7], v48 offset:0
    ds_read_b128 v[12:15], v48 offset:128
    ds_read_b128 v[8:11], v48 offset:32
    ds_read_b128 v[16:19], v48 offset:160
    s_waitcnt lgkmcnt(2)
    v_pk_fma_f32 v[52:53], v[36:37], v[4:5], v[12:13] op_sel:[1,0,0] op_sel_hi:[1,1,1]
    v_pk_fma_f32 v[54:55], v[36:37], v[6:7], v[14:15] op_sel:[1,0,0] op_sel_hi:[1,1,1]
    s_waitcnt lgkmcnt(0)
    v_pk_fma_f32 v[56:57], v[36:37], v[8:9], v[16:17] op_sel:[1,0,0] op_sel_hi:[1,1,1]
    v_pk_fma_f32 v[58:59], v[36:37], v[10:11], v[18:19] op_sel:[1,0,0] op_sel_hi:[1,1,1]
    ds_read_b128 v[20:23], v48 offset:64
    ds_read_b128 v[28:31], v48 offset:192
    ds_read_b128 v[24:27], v48 offset:96
    ds_read_b128 v[32:35], v48 offset:224
    v_pk_fma_f32 v[64:65], v[64:65], v[36:37], v[52:53] op_sel_hi:[1,0,1]
    v_pk_fma_f32 v[66:67], v[66:67], v[36:37], v[54:55] op_sel_hi:[1,0,1]
    v_pk_fma_f32 v[68:69], v[68:69], v[36:37], v[56:57] op_sel_hi:[1,0,1]
    v_pk_fma_f32 v[70:71], v[70:71], v[36:37], v[58:59] op_sel_hi:[1,0,1]
    v_pk_mul_f32 v[52:53], v[64:65], v[64:65]
    v_pk_mul_f32 v[54:55], v[66:67], v[66:67]
    v_pk_mul_f32 v[56:57], v[68:69], v[68:69]
    v_pk_mul_f32 v[58:59], v[70:71], v[70:71]
    s_add_u32 m0, s24, 36864
    s_add_u32 s12, s12, 0x8000
    v_pk_fma_f32 v[52:53], v[52:53], s[80:81], s[80:81] op_sel:[0,0,1] op_sel_hi:[1,0,1]
    buffer_load_dwordx4 v40, s[40:43], s12 offen offset:0 lds
    v_pk_fma_f32 v[54:55], v[54:55], s[80:81], s[80:81] op_sel:[0,0,1] op_sel_hi:[1,0,1]
    v_pk_fma_f32 v[56:57], v[56:57], s[80:81], s[80:81] op_sel:[0,0,1] op_sel_hi:[1,0,1]
    v_pk_fma_f32 v[58:59], v[58:59], s[80:81], s[80:81] op_sel:[0,0,1] op_sel_hi:[1,0,1]
    v_pk_mul_f32 v[52:53], v[64:65], v[52:53]
    v_pk_mul_f32 v[54:55], v[66:67], v[54:55]
    v_pk_mul_f32 v[56:57], v[68:69], v[56:57]
    v_pk_mul_f32 v[58:59], v[70:71], v[58:59]
    v_exp_f32 v52, v52
    v_exp_f32 v53, v53
    buffer_load_dwordx4 v41, s[40:43], s12 offen offset:1024 lds
    v_exp_f32 v54, v54
    v_exp_f32 v55, v55
    v_exp_f32 v56, v56
    v_exp_f32 v57, v57
    v_exp_f32 v58, v58
    v_exp_f32 v59, v59
    v_pk_add_f32 v[52:53], v[52:53], 1.0 op_sel_hi:[1,0]
    v_pk_add_f32 v[54:55], v[54:55], 1.0 op_sel_hi:[1,0]
    v_pk_add_f32 v[56:57], v[56:57], 1.0 op_sel_hi:[1,0]
    buffer_load_dwordx4 v42, s[40:43], s12 offen offset:2048 lds
    v_pk_add_f32 v[58:59], v[58:59], 1.0 op_sel_hi:[1,0]
    v_rcp_f32 v52, v52
    v_rcp_f32 v53, v53
    v_rcp_f32 v54, v54
    v_rcp_f32 v55, v55
    v_rcp_f32 v56, v56
    v_rcp_f32 v57, v57
    v_rcp_f32 v58, v58
    v_rcp_f32 v59, v59
    buffer_load_dwordx4 v43, s[40:43], s12 offen offset:3072 lds
    v_pk_mul_f32 v[52:53], v[64:65], v[52:53]
    v_pk_mul_f32 v[54:55], v[66:67], v[54:55]
    v_pk_mul_f32 v[56:57], v[68:69], v[56:57]
    v_pk_mul_f32 v[58:59], v[70:71], v[58:59]
    v_cvt_pk_bf16_f32 v64, v52, v53
    v_cvt_pk_bf16_f32 v65, v54, v55
    v_cvt_pk_bf16_f32 v66, v56, v57
    v_cvt_pk_bf16_f32 v67, v58, v59
    buffer_store_dwordx4 v[64:67], v46, s[44:47], s68 offen offset:0 sc1
    s_waitcnt lgkmcnt(2)
    v_pk_fma_f32 v[52:53], v[36:37], v[20:21], v[28:29] op_sel:[1,0,0] op_sel_hi:[1,1,1]
    v_pk_fma_f32 v[54:55], v[36:37], v[22:23], v[30:31] op_sel:[1,0,0] op_sel_hi:[1,1,1]
    s_waitcnt lgkmcnt(0)
    v_pk_fma_f32 v[56:57], v[36:37], v[24:25], v[32:33] op_sel:[1,0,0] op_sel_hi:[1,1,1]
    v_pk_fma_f32 v[58:59], v[36:37], v[26:27], v[34:35] op_sel:[1,0,0] op_sel_hi:[1,1,1]
    s_barrier
    ds_read_b128 v[4:7], v49 offset:0
    ds_read_b128 v[12:15], v49 offset:128
    ds_read_b128 v[8:11], v49 offset:32
    ds_read_b128 v[16:19], v49 offset:160
    v_pk_fma_f32 v[72:73], v[72:73], v[36:37], v[52:53] op_sel_hi:[1,0,1]
    v_pk_fma_f32 v[74:75], v[74:75], v[36:37], v[54:55] op_sel_hi:[1,0,1]
    v_pk_fma_f32 v[76:77], v[76:77], v[36:37], v[56:57] op_sel_hi:[1,0,1]
    v_pk_fma_f32 v[78:79], v[78:79], v[36:37], v[58:59] op_sel_hi:[1,0,1]
    v_pk_mul_f32 v[52:53], v[72:73], v[72:73]
    v_pk_mul_f32 v[54:55], v[74:75], v[74:75]
    v_pk_mul_f32 v[56:57], v[76:77], v[76:77]
    v_pk_mul_f32 v[58:59], v[78:79], v[78:79]
    s_add_u32 m0, s24, 0
    s_lshl4_add_u32 s12, s18, s23
    v_pk_fma_f32 v[52:53], v[52:53], s[80:81], s[80:81] op_sel:[0,0,1] op_sel_hi:[1,0,1]
    buffer_load_dwordx4 v40, s[40:43], s12 offen offset:0 lds
    v_pk_fma_f32 v[54:55], v[54:55], s[80:81], s[80:81] op_sel:[0,0,1] op_sel_hi:[1,0,1]
    v_pk_fma_f32 v[56:57], v[56:57], s[80:81], s[80:81] op_sel:[0,0,1] op_sel_hi:[1,0,1]
    v_pk_fma_f32 v[58:59], v[58:59], s[80:81], s[80:81] op_sel:[0,0,1] op_sel_hi:[1,0,1]
    v_pk_mul_f32 v[52:53], v[72:73], v[52:53]
    v_pk_mul_f32 v[54:55], v[74:75], v[54:55]
    v_pk_mul_f32 v[56:57], v[76:77], v[56:57]
    v_pk_mul_f32 v[58:59], v[78:79], v[58:59]
    v_exp_f32 v52, v52
    v_exp_f32 v53, v53
    buffer_load_dwordx4 v41, s[40:43], s12 offen offset:1024 lds
    v_exp_f32 v54, v54
    v_exp_f32 v55, v55
    v_exp_f32 v56, v56
    v_exp_f32 v57, v57
    v_exp_f32 v58, v58
    v_exp_f32 v59, v59
    v_pk_add_f32 v[52:53], v[52:53], 1.0 op_sel_hi:[1,0]
    v_pk_add_f32 v[54:55], v[54:55], 1.0 op_sel_hi:[1,0]
    v_pk_add_f32 v[56:57], v[56:57], 1.0 op_sel_hi:[1,0]
    buffer_load_dwordx4 v42, s[40:43], s12 offen offset:2048 lds
    v_pk_add_f32 v[58:59], v[58:59], 1.0 op_sel_hi:[1,0]
    v_rcp_f32 v52, v52
    v_rcp_f32 v53, v53
    v_rcp_f32 v54, v54
    v_rcp_f32 v55, v55
    v_rcp_f32 v56, v56
    v_rcp_f32 v57, v57
    v_rcp_f32 v58, v58
    v_rcp_f32 v59, v59
    buffer_load_dwordx4 v43, s[40:43], s12 offen offset:3072 lds
    v_pk_mul_f32 v[52:53], v[72:73], v[52:53]
    v_pk_mul_f32 v[54:55], v[74:75], v[54:55]
    v_pk_mul_f32 v[56:57], v[76:77], v[56:57]
    v_pk_mul_f32 v[58:59], v[78:79], v[58:59]
    v_cvt_pk_bf16_f32 v72, v52, v53
    v_cvt_pk_bf16_f32 v73, v54, v55
    v_cvt_pk_bf16_f32 v74, v56, v57
    v_cvt_pk_bf16_f32 v75, v58, v59
    buffer_store_dwordx4 v[72:75], v46, s[44:47], s68 offen offset:1024 sc1
    s_waitcnt lgkmcnt(2)
    v_pk_fma_f32 v[52:53], v[36:37], v[4:5], v[12:13] op_sel:[1,0,0] op_sel_hi:[1,1,1]
    v_pk_fma_f32 v[54:55], v[36:37], v[6:7], v[14:15] op_sel:[1,0,0] op_sel_hi:[1,1,1]
    s_waitcnt lgkmcnt(0)
    v_pk_fma_f32 v[56:57], v[36:37], v[8:9], v[16:17] op_sel:[1,0,0] op_sel_hi:[1,1,1]
    v_pk_fma_f32 v[58:59], v[36:37], v[10:11], v[18:19] op_sel:[1,0,0] op_sel_hi:[1,1,1]
    ds_read_b128 v[20:23], v49 offset:64
    ds_read_b128 v[28:31], v49 offset:192
    ds_read_b128 v[24:27], v49 offset:96
    ds_read_b128 v[32:35], v49 offset:224
    v_pk_fma_f32 v[80:81], v[80:81], v[36:37], v[52:53] op_sel_hi:[1,0,1]
    v_pk_fma_f32 v[82:83], v[82:83], v[36:37], v[54:55] op_sel_hi:[1,0,1]
    v_pk_fma_f32 v[84:85], v[84:85], v[36:37], v[56:57] op_sel_hi:[1,0,1]
    v_pk_fma_f32 v[86:87], v[86:87], v[36:37], v[58:59] op_sel_hi:[1,0,1]
    v_pk_mul_f32 v[52:53], v[80:81], v[80:81]
    v_pk_mul_f32 v[54:55], v[82:83], v[82:83]
    v_pk_mul_f32 v[56:57], v[84:85], v[84:85]
    v_pk_mul_f32 v[58:59], v[86:87], v[86:87]
    s_add_u32 m0, s24, 4096
    s_add_u32 s12, s12, 0x8000
    v_pk_fma_f32 v[52:53], v[52:53], s[80:81], s[80:81] op_sel:[0,0,1] op_sel_hi:[1,0,1]
    buffer_load_dwordx4 v40, s[40:43], s12 offen offset:0 lds
    v_pk_fma_f32 v[54:55], v[54:55], s[80:81], s[80:81] op_sel:[0,0,1] op_sel_hi:[1,0,1]
    v_pk_fma_f32 v[56:57], v[56:57], s[80:81], s[80:81] op_sel:[0,0,1] op_sel_hi:[1,0,1]
    v_pk_fma_f32 v[58:59], v[58:59], s[80:81], s[80:81] op_sel:[0,0,1] op_sel_hi:[1,0,1]
    v_pk_mul_f32 v[52:53], v[80:81], v[52:53]
    v_pk_mul_f32 v[54:55], v[82:83], v[54:55]
    v_pk_mul_f32 v[56:57], v[84:85], v[56:57]
    v_pk_mul_f32 v[58:59], v[86:87], v[58:59]
    v_exp_f32 v52, v52
    v_exp_f32 v53, v53
    buffer_load_dwordx4 v41, s[40:43], s12 offen offset:1024 lds
    v_exp_f32 v54, v54
    v_exp_f32 v55, v55
    v_exp_f32 v56, v56
    v_exp_f32 v57, v57
    v_exp_f32 v58, v58
    v_exp_f32 v59, v59
    v_pk_add_f32 v[52:53], v[52:53], 1.0 op_sel_hi:[1,0]
    v_pk_add_f32 v[54:55], v[54:55], 1.0 op_sel_hi:[1,0]
    v_pk_add_f32 v[56:57], v[56:57], 1.0 op_sel_hi:[1,0]
    buffer_load_dwordx4 v42, s[40:43], s12 offen offset:2048 lds
    v_pk_add_f32 v[58:59], v[58:59], 1.0 op_sel_hi:[1,0]
    v_rcp_f32 v52, v52
    v_rcp_f32 v53, v53
    v_rcp_f32 v54, v54
    v_rcp_f32 v55, v55
    v_rcp_f32 v56, v56
    v_rcp_f32 v57, v57
    v_rcp_f32 v58, v58
    v_rcp_f32 v59, v59
    buffer_load_dwordx4 v43, s[40:43], s12 offen offset:3072 lds
    v_pk_mul_f32 v[52:53], v[80:81], v[52:53]
    v_pk_mul_f32 v[54:55], v[82:83], v[54:55]
    v_pk_mul_f32 v[56:57], v[84:85], v[56:57]
    v_pk_mul_f32 v[58:59], v[86:87], v[58:59]
    v_cvt_pk_bf16_f32 v80, v52, v53
    v_cvt_pk_bf16_f32 v81, v54, v55
    v_cvt_pk_bf16_f32 v82, v56, v57
    v_cvt_pk_bf16_f32 v83, v58, v59
    buffer_store_dwordx4 v[80:83], v46, s[44:47], s69 offen offset:0 sc1
    s_waitcnt lgkmcnt(2)
    v_pk_fma_f32 v[52:53], v[36:37], v[20:21], v[28:29] op_sel:[1,0,0] op_sel_hi:[1,1,1]
    v_pk_fma_f32 v[54:55], v[36:37], v[22:23], v[30:31] op_sel:[1,0,0] op_sel_hi:[1,1,1]
    s_waitcnt lgkmcnt(0)
    v_pk_fma_f32 v[56:57], v[36:37], v[24:25], v[32:33] op_sel:[1,0,0] op_sel_hi:[1,1,1]
    v_pk_fma_f32 v[58:59], v[36:37], v[26:27], v[34:35] op_sel:[1,0,0] op_sel_hi:[1,1,1]
    ds_read_b128 v[4:7], v50 offset:0
    ds_read_b128 v[12:15], v50 offset:128
    ds_read_b128 v[8:11], v50 offset:32
    ds_read_b128 v[16:19], v50 offset:160
    v_pk_fma_f32 v[88:89], v[88:89], v[36:37], v[52:53] op_sel_hi:[1,0,1]
    v_pk_fma_f32 v[90:91], v[90:91], v[36:37], v[54:55] op_sel_hi:[1,0,1]
    v_pk_fma_f32 v[92:93], v[92:93], v[36:37], v[56:57] op_sel_hi:[1,0,1]
    v_pk_fma_f32 v[94:95], v[94:95], v[36:37], v[58:59] op_sel_hi:[1,0,1]
    v_pk_mul_f32 v[52:53], v[88:89], v[88:89]
    v_pk_mul_f32 v[54:55], v[90:91], v[90:91]
    v_pk_mul_f32 v[56:57], v[92:93], v[92:93]
    v_pk_mul_f32 v[58:59], v[94:95], v[94:95]
    s_add_u32 m0, s24, 16384
    s_lshl4_add_u32 s12, s19, s23
    v_pk_fma_f32 v[52:53], v[52:53], s[80:81], s[80:81] op_sel:[0,0,1] op_sel_hi:[1,0,1]
    buffer_load_dwordx4 v40, s[40:43], s12 offen offset:0 lds
    v_pk_fma_f32 v[54:55], v[54:55], s[80:81], s[80:81] op_sel:[0,0,1] op_sel_hi:[1,0,1]
    v_pk_fma_f32 v[56:57], v[56:57], s[80:81], s[80:81] op_sel:[0,0,1] op_sel_hi:[1,0,1]
    v_pk_fma_f32 v[58:59], v[58:59], s[80:81], s[80:81] op_sel:[0,0,1] op_sel_hi:[1,0,1]
    v_pk_mul_f32 v[52:53], v[88:89], v[52:53]
    v_pk_mul_f32 v[54:55], v[90:91], v[54:55]
    v_pk_mul_f32 v[56:57], v[92:93], v[56:57]
    v_pk_mul_f32 v[58:59], v[94:95], v[58:59]
    v_exp_f32 v52, v52
    v_exp_f32 v53, v53
    buffer_load_dwordx4 v41, s[40:43], s12 offen offset:1024 lds
    v_exp_f32 v54, v54
    v_exp_f32 v55, v55
    v_exp_f32 v56, v56
    v_exp_f32 v57, v57
    v_exp_f32 v58, v58
    v_exp_f32 v59, v59
    v_pk_add_f32 v[52:53], v[52:53], 1.0 op_sel_hi:[1,0]
    v_pk_add_f32 v[54:55], v[54:55], 1.0 op_sel_hi:[1,0]
    v_pk_add_f32 v[56:57], v[56:57], 1.0 op_sel_hi:[1,0]
    buffer_load_dwordx4 v42, s[40:43], s12 offen offset:2048 lds
    v_pk_add_f32 v[58:59], v[58:59], 1.0 op_sel_hi:[1,0]
    v_rcp_f32 v52, v52
    v_rcp_f32 v53, v53
    v_rcp_f32 v54, v54
    v_rcp_f32 v55, v55
    v_rcp_f32 v56, v56
    v_rcp_f32 v57, v57
    v_rcp_f32 v58, v58
    v_rcp_f32 v59, v59
    buffer_load_dwordx4 v43, s[40:43], s12 offen offset:3072 lds
    v_pk_mul_f32 v[52:53], v[88:89], v[52:53]
    v_pk_mul_f32 v[54:55], v[90:91], v[54:55]
    v_pk_mul_f32 v[56:57], v[92:93], v[56:57]
    v_pk_mul_f32 v[58:59], v[94:95], v[58:59]
    v_cvt_pk_bf16_f32 v88, v52, v53
    v_cvt_pk_bf16_f32 v89, v54, v55
    v_cvt_pk_bf16_f32 v90, v56, v57
    v_cvt_pk_bf16_f32 v91, v58, v59
    buffer_store_dwordx4 v[88:91], v46, s[44:47], s69 offen offset:1024 sc1
    s_waitcnt lgkmcnt(2)
    v_pk_fma_f32 v[52:53], v[36:37], v[4:5], v[12:13] op_sel:[1,0,0] op_sel_hi:[1,1,1]
    v_pk_fma_f32 v[54:55], v[36:37], v[6:7], v[14:15] op_sel:[1,0,0] op_sel_hi:[1,1,1]
    s_waitcnt lgkmcnt(0)
    v_pk_fma_f32 v[56:57], v[36:37], v[8:9], v[16:17] op_sel:[1,0,0] op_sel_hi:[1,1,1]
    v_pk_fma_f32 v[58:59], v[36:37], v[10:11], v[18:19] op_sel:[1,0,0] op_sel_hi:[1,1,1]
    ds_read_b128 v[20:23], v50 offset:64
    ds_read_b128 v[28:31], v50 offset:192
    ds_read_b128 v[24:27], v50 offset:96
    ds_read_b128 v[32:35], v50 offset:224
    v_pk_fma_f32 v[96:97], v[96:97], v[36:37], v[52:53] op_sel_hi:[1,0,1]
    v_pk_fma_f32 v[98:99], v[98:99], v[36:37], v[54:55] op_sel_hi:[1,0,1]
    v_pk_fma_f32 v[100:101], v[100:101], v[36:37], v[56:57] op_sel_hi:[1,0,1]
    v_pk_fma_f32 v[102:103], v[102:103], v[36:37], v[58:59] op_sel_hi:[1,0,1]
    v_pk_mul_f32 v[52:53], v[96:97], v[96:97]
    v_pk_mul_f32 v[54:55], v[98:99], v[98:99]
    v_pk_mul_f32 v[56:57], v[100:101], v[100:101]
    v_pk_mul_f32 v[58:59], v[102:103], v[102:103]
    s_add_u32 m0, s24, 20480
    s_add_u32 s12, s12, 0x8000
    v_pk_fma_f32 v[52:53], v[52:53], s[80:81], s[80:81] op_sel:[0,0,1] op_sel_hi:[1,0,1]
    buffer_load_dwordx4 v40, s[40:43], s12 offen offset:0 lds
    v_pk_fma_f32 v[54:55], v[54:55], s[80:81], s[80:81] op_sel:[0,0,1] op_sel_hi:[1,0,1]
    v_pk_fma_f32 v[56:57], v[56:57], s[80:81], s[80:81] op_sel:[0,0,1] op_sel_hi:[1,0,1]
    v_pk_fma_f32 v[58:59], v[58:59], s[80:81], s[80:81] op_sel:[0,0,1] op_sel_hi:[1,0,1]
    v_pk_mul_f32 v[52:53], v[96:97], v[52:53]
    v_pk_mul_f32 v[54:55], v[98:99], v[54:55]
    v_pk_mul_f32 v[56:57], v[100:101], v[56:57]
    v_pk_mul_f32 v[58:59], v[102:103], v[58:59]
    v_exp_f32 v52, v52
    v_exp_f32 v53, v53
    buffer_load_dwordx4 v41, s[40:43], s12 offen offset:1024 lds
    v_exp_f32 v54, v54
    v_exp_f32 v55, v55
    v_exp_f32 v56, v56
    v_exp_f32 v57, v57
    v_exp_f32 v58, v58
    v_exp_f32 v59, v59
    v_pk_add_f32 v[52:53], v[52:53], 1.0 op_sel_hi:[1,0]
    v_pk_add_f32 v[54:55], v[54:55], 1.0 op_sel_hi:[1,0]
    v_pk_add_f32 v[56:57], v[56:57], 1.0 op_sel_hi:[1,0]
    buffer_load_dwordx4 v42, s[40:43], s12 offen offset:2048 lds
    v_pk_add_f32 v[58:59], v[58:59], 1.0 op_sel_hi:[1,0]
    v_rcp_f32 v52, v52
    v_rcp_f32 v53, v53
    v_rcp_f32 v54, v54
    v_rcp_f32 v55, v55
    v_rcp_f32 v56, v56
    v_rcp_f32 v57, v57
    v_rcp_f32 v58, v58
    v_rcp_f32 v59, v59
    buffer_load_dwordx4 v43, s[40:43], s12 offen offset:3072 lds
    v_pk_mul_f32 v[52:53], v[96:97], v[52:53]
    v_pk_mul_f32 v[54:55], v[98:99], v[54:55]
    v_pk_mul_f32 v[56:57], v[100:101], v[56:57]
    v_pk_mul_f32 v[58:59], v[102:103], v[58:59]
    v_cvt_pk_bf16_f32 v96, v52, v53
    v_cvt_pk_bf16_f32 v97, v54, v55
    v_cvt_pk_bf16_f32 v98, v56, v57
    v_cvt_pk_bf16_f32 v99, v58, v59
    buffer_store_dwordx4 v[96:99], v46, s[44:47], s70 offen offset:0 sc1
    s_waitcnt lgkmcnt(2)
    v_pk_fma_f32 v[52:53], v[36:37], v[20:21], v[28:29] op_sel:[1,0,0] op_sel_hi:[1,1,1]
    v_pk_fma_f32 v[54:55], v[36:37], v[22:23], v[30:31] op_sel:[1,0,0] op_sel_hi:[1,1,1]
    s_waitcnt lgkmcnt(0)
    v_pk_fma_f32 v[56:57], v[36:37], v[24:25], v[32:33] op_sel:[1,0,0] op_sel_hi:[1,1,1]
    v_pk_fma_f32 v[58:59], v[36:37], v[26:27], v[34:35] op_sel:[1,0,0] op_sel_hi:[1,1,1]
    v_pk_fma_f32 v[104:105], v[104:105], v[36:37], v[52:53] op_sel_hi:[1,0,1]
    v_pk_fma_f32 v[106:107], v[106:107], v[36:37], v[54:55] op_sel_hi:[1,0,1]
    v_pk_fma_f32 v[108:109], v[108:109], v[36:37], v[56:57] op_sel_hi:[1,0,1]
    v_pk_fma_f32 v[110:111], v[110:111], v[36:37], v[58:59] op_sel_hi:[1,0,1]
    v_pk_mul_f32 v[52:53], v[104:105], v[104:105]
    v_pk_mul_f32 v[54:55], v[106:107], v[106:107]
    v_pk_mul_f32 v[56:57], v[108:109], v[108:109]
    v_pk_mul_f32 v[58:59], v[110:111], v[110:111]
    v_pk_fma_f32 v[52:53], v[52:53], s[80:81], s[80:81] op_sel:[0,0,1] op_sel_hi:[1,0,1]
    v_pk_fma_f32 v[54:55], v[54:55], s[80:81], s[80:81] op_sel:[0,0,1] op_sel_hi:[1,0,1]
    v_pk_fma_f32 v[56:57], v[56:57], s[80:81], s[80:81] op_sel:[0,0,1] op_sel_hi:[1,0,1]
    v_pk_fma_f32 v[58:59], v[58:59], s[80:81], s[80:81] op_sel:[0,0,1] op_sel_hi:[1,0,1]
    v_pk_mul_f32 v[52:53], v[104:105], v[52:53]
    v_pk_mul_f32 v[54:55], v[106:107], v[54:55]
    v_pk_mul_f32 v[56:57], v[108:109], v[56:57]
    v_pk_mul_f32 v[58:59], v[110:111], v[58:59]
    v_exp_f32 v52, v52
    v_exp_f32 v53, v53
    v_exp_f32 v54, v54
    v_exp_f32 v55, v55
    v_exp_f32 v56, v56
    v_exp_f32 v57, v57
    v_exp_f32 v58, v58
    v_exp_f32 v59, v59
    v_pk_add_f32 v[52:53], v[52:53], 1.0 op_sel_hi:[1,0]
    v_pk_add_f32 v[54:55], v[54:55], 1.0 op_sel_hi:[1,0]
    v_pk_add_f32 v[56:57], v[56:57], 1.0 op_sel_hi:[1,0]
    v_pk_add_f32 v[58:59], v[58:59], 1.0 op_sel_hi:[1,0]
    v_rcp_f32 v52, v52
    v_rcp_f32 v53, v53
    v_rcp_f32 v54, v54
    v_rcp_f32 v55, v55
    v_rcp_f32 v56, v56
    v_rcp_f32 v57, v57
    v_rcp_f32 v58, v58
    v_rcp_f32 v59, v59
    v_pk_mul_f32 v[52:53], v[104:105], v[52:53]
    v_pk_mul_f32 v[54:55], v[106:107], v[54:55]
    v_pk_mul_f32 v[56:57], v[108:109], v[56:57]
    v_pk_mul_f32 v[58:59], v[110:111], v[58:59]
    v_cvt_pk_bf16_f32 v104, v52, v53
    v_cvt_pk_bf16_f32 v105, v54, v55
    v_cvt_pk_bf16_f32 v106, v56, v57
    v_cvt_pk_bf16_f32 v107, v58, v59
    buffer_store_dwordx4 v[104:107], v46, s[44:47], s70 offen offset:1024 sc1
    s_branch L_gelu_done
L_st_slow3:
    s_mov_b32 s28, 0
L_st_poll3:
    buffer_load_dwordx4 v[28:31], v32, s[44:47], s26 offen sc1
    s_add_u32 s28, s28, 1
    s_cmp_gt_u32 s28, 0x80000
    s_cbranch_scc1 L_end
    s_waitcnt vmcnt(0)
    v_cmp_ne_u32 s[98:99], s25, v29
    v_cmp_ne_u32 vcc, s25, v31
    s_nop 2
    s_or_b64 vcc, vcc, s[98:99]
    s_cbranch_scc1 L_st_poll3
    s_branch L_st_ok3
L_st_slow4:
    s_mov_b32 s28, 0
L_st_poll4:
    buffer_load_dwordx4 v[28:31], v32, s[44:47], s26 offen sc1
    s_add_u32 s28, s28, 1
    s_cmp_gt_u32 s28, 0x80000
    s_cbranch_scc1 L_end
    s_waitcnt vmcnt(0)
    v_cmp_ne_u32 s[98:99], s25, v29
    v_cmp_ne_u32 vcc, s25, v31
    s_nop 2
    s_or_b64 vcc, vcc, s[98:99]
    s_cbranch_scc1 L_st_poll4
    s_branch L_st_ok4
L_h_slow:
    s_mov_b32 s28, 0
    buffer_load_dword v51, v50, s[44:47], 0 offen sc1
L_h_poll:
    s_waitcnt vmcnt(1)
    v_cmp_ne_u32 vcc, s25, v58
    s_nop 1
    s_cbranch_vccz L_h_ready
    buffer_load_dword v58, v50, s[44:47], 0 offen sc1
    s_waitcnt vmcnt(1)
    v_cmp_ne_u32 vcc, s25, v51
    s_nop 1
    s_cbranch_vccz L_h_ready
    buffer_load_dword v51, v50, s[44:47], 0 offen sc1
    s_add_u32 s28, s28, 1
    s_cmp_gt_u32 s28, 0x40000
    s_cbranch_scc0 L_h_poll
    s_branch L_end
L_z_slow:
    s_mov_b32 s28, 0
L_z_poll:
    buffer_load_dword v51, v55, s[44:47], 0 offen sc1
    s_add_u32 s28, s28, 1
    s_cmp_gt_u32 s28, 0x80000
    s_cbranch_scc1 L_end
    s_waitcnt vmcnt(0)
    v_cmp_ne_u32 vcc, s25, v51
    s_nop 1
    s_cbranch_vccnz L_z_poll
    s_branch L_z_ready
L_e_check:
    s_mov_b32 s28, 0
L_e_poll:
    s_waitcnt vmcnt(0)
    v_cmp_ne_u32 vcc, s25, v38
    s_nop 1
    s_cbranch_vccz L_e_ok
    buffer_load_dword v38, v1, s[44:47], s26 offen sc1
    s_add_u32 s28, s28, 1
    s_cmp_gt_u32 s28, 0x80000
    s_cbranch_scc0 L_e_poll
    s_branch L_end
L_e_store:
    v_mov_b32 v1, 7536640
    v_mov_b32 v2, s25
    s_mov_b64 exec, 1
    buffer_store_dword v2, v1, s[44:47], 0 offen sc1
    s_mov_b64 exec, -1
    s_branch L_e_done
L_last:
.section .rodata,"a"
.p2align 6
.amdhsa_kernel recurrent_scan__spectral_fnet__mixer_channel_mlp__prompt_kernel
  .amdhsa_next_free_vgpr 512
  .amdhsa_next_free_sgpr 102
  .amdhsa_accum_offset 256
  .amdhsa_group_segment_fixed_size 0
  .amdhsa_kernarg_size 104
  .amdhsa_user_sgpr_count 2
  .amdhsa_user_sgpr_kernarg_segment_ptr 1
  .amdhsa_system_sgpr_workgroup_id_x 1
.end_amdhsa_kernel
```
